```python
import torch

def _softmax(x, axis=-1):
    return torch.softmax(x, dim=axis)
def _gelu(x):
    return torch.nn.functional.gelu(x, approximate="tanh")
def _silu(x):
    return torch.nn.functional.silu(x)
def _sigmoid(x):
    return torch.sigmoid(x)
def _layernorm(x, axis=-1, eps=1e-5):
    m = x.mean(dim=axis, keepdim=True)
    v = x.var(dim=axis, keepdim=True, unbiased=False)
    return (x - m) / torch.sqrt(v + eps)
def _scatter_add(tgt, idx, src, axis=0):
    return tgt.clone().index_add_(axis, idx, src)
def _segment_sum(src, seg, n):
    out = torch.zeros((n,) + src.shape[1:], dtype=src.dtype)
    return out.index_add_(0, seg, src)
def _pad(x, pw):
    flat = tuple(v for pair in reversed(pw) for v in pair)
    return torch.nn.functional.pad(x, flat)

kernel_name = 'recurrent_scan__sliding_block__dense_activation_relu__prompt'

def setup_inputs():

    _w = (lambda a: (lambda t: t.to(torch.bfloat16) if t.is_floating_point() else t)(torch.as_tensor(a)))
    def _A_setup():
        B, S, D = 1, 2048, 512
        return {
            "x": _w((lambda *s: torch.randn(*s, dtype=torch.bfloat16) * 0.05)(B, S, D)),
            "wqkv": _w((lambda *s: torch.randn(*s, dtype=torch.bfloat16) * 0.05)(D, 3 * D)),
            "wo": _w((lambda *s: torch.randn(*s, dtype=torch.bfloat16) * 0.05)(D, D)),
        }
    _A_in = _A_setup()

    def _B_setup():
        B, S, D, Dff = 1, 2048, 512, 1792
        return {
            "x": _w((lambda *s: torch.randn(*s, dtype=torch.bfloat16) * 0.05)(B, S, D)),
            "w1": _w((lambda *s: torch.randn(*s, dtype=torch.bfloat16) * 0.05)(D, Dff)),
            "w2": _w((lambda *s: torch.randn(*s, dtype=torch.bfloat16) * 0.05)(Dff, D)),
        }
    _B_in = _B_setup()

    return {
        "A_x": _A_in["x"],
        "A_wqkv": _A_in["wqkv"],
        "A_wo": _A_in["wo"],
        "B_x": _B_in["x"],
        "B_w1": _B_in["w1"],
        "B_w2": _B_in["w2"],
    }

def reference(A_x, A_wqkv, A_wo, B_x, B_w1, B_w2):
    def _A_ref(x, wqkv, wo):
        B, S, D = x.shape
        H = 32; Dh = D // H; W = 256
        qkv = (lambda x, *d: x.permute(*d))((x @ wqkv).reshape(B, S, 3, H, Dh), 2, 0, 3, 1, 4)
        q, k, v = qkv[0], qkv[1], qkv[2]
        scores = torch.einsum("bhqd,bhkd->bhqk", q, k) * (Dh ** -0.5)
        idx = torch.arange(S)
        mask = (idx[:, None] - idx[None, :] >= 0) & (idx[:, None] - idx[None, :] < W)
        scores = torch.where(mask[None, None], scores, -1e9)
        p = _softmax(scores, axis=-1)
        o = torch.einsum("bhqk,bhkd->bhqd", p, v)
        return (lambda x, *d: x.permute(*d))(o, 0, 2, 1, 3).reshape(B, S, D) @ wo

    def _B_ref(x, w1, w2):
        h = torch.einsum("bsd,df->bsf", x, w1)
        zero = torch.zeros_like(h)
        h = torch.maximum(h, zero)
        return torch.einsum("bsf,fd->bsd", h, w2)

    x = A_x
    xn = _layernorm(x, axis=-1)
    s = _A_ref(xn, A_wqkv, A_wo)
    g = _silu(_B_ref(xn, B_w1, B_w2))
    return x + s * g
```

```asm
; @launch grid=(256,1,1) block=(256,1,1) lds=163840
.amdgcn_target "amdgcn-amd-amdhsa--gfx950"
.text
.globl recurrent_scan__sliding_block__dense_activation_relu__prompt_kernel
.p2align 8
.type recurrent_scan__sliding_block__dense_activation_relu__prompt_kernel,@function
recurrent_scan__sliding_block__dense_activation_relu__prompt_kernel:
    s_cmp_ge_u32 s2, 256
    s_cbranch_scc1 L_end
    s_load_dwordx16 s[64:79], s[0:1], 0
    s_load_dwordx2 s[80:81], s[0:1], 64
    s_getpc_b64 s[36:37]
L_pc0:
    v_lshrrev_b32 v2, 6, v0
    v_and_b32 v1, 63, v0
    s_and_b32 s3, s2, 7
    s_lshr_b32 s7, s2, 3
    v_readfirstlane_b32 s6, v2
    s_and_b32 s4, s3, 1
    s_lshl_b32 s4, s4, 3
    s_add_u32 s38, s7, 0
    s_and_b32 s38, s38, 7
    s_add_u32 s4, s4, s38
    s_lshr_b32 s5, s3, 1
    s_lshl_b32 s5, s5, 2
    s_lshr_b32 s38, s7, 3
    s_add_u32 s5, s5, s38
    s_mov_b32 s56, s36
    s_and_b32 s57, s37, 0xffff
    s_mov_b32 s58, L_end-L_pc0
    s_mov_b32 s59, 0x20000
    s_lshl_b32 s38, s7, 2
    s_add_u32 s38, s38, s6
    s_lshl_b32 s38, s38, 10
    s_mov_b32 s99, s7
    s_mov_b32 s55, 0
    v_lshlrev_b32 v2, 4, v1
    buffer_load_dwordx4 v[244:247], v2, s[56:59], s38 offen
    s_lshr_b32 s40, s6, 1
    s_and_b32 s41, s6, 1
    s_lshl_b32 s42, s5, 2
    v_lshrrev_b32 v2, 3, v1
    v_and_b32 v3, 7, v1
    v_lshrrev_b32 v4, 4, v1
    v_xor_b32 v4, v3, v4
    v_lshlrev_b32 v4, 4, v4
    v_lshl_add_u32 v8, v2, 10, v4
    v_xor_b32 v5, 64, v8
    v_add_u32 v9, 0x2000, v5
    v_add_u32 v10, 0x4000, v8
    v_add_u32 v11, 0x6000, v5
    v_bfe_u32 v4, v1, 4, 1
    v_lshlrev_b32 v4, 2, v4
    v_xor_b32 v4, v3, v4
    v_lshlrev_b32 v4, 4, v4
    v_lshl_add_u32 v252, v2, 10, v4
    v_mul_u32_u24 v5, 0xc00, v2
    v_add_u32 v12, v5, v4
    v_add_u32 v13, 24576, v12
    v_mul_u32_u24 v5, 0xe00, v2
    v_add_u32 v15, v5, v4
    v_add_u32 v29, 28672, v15
    v_lshrrev_b32 v2, 2, v1
    v_and_b32 v3, 3, v1
    v_lshlrev_b32 v3, 4, v3
    v_mul_u32_u24 v5, 0xc00, v2
    v_add_u32 v14, v5, v3
    s_lshr_b32 s39, s4, 1
    s_lshl_b32 s36, s4, 7
    s_lshl_b32 s37, s6, 5
    s_add_u32 s36, s36, s37
    s_lshl_b32 s36, s36, 10
    s_add_u32 s48, s36, 1024
    s_lshl_b32 s37, s39, 7
    s_add_u32 s43, s36, s37
    s_lshl_b32 s36, s39, 2
    s_add_u32 s36, s36, s6
    s_mul_i32 s37, s36, 49152
    s_and_b32 s38, s5, 1
    s_add_u32 s38, s38, 1
    s_lshl_b32 s38, s38, 10
    s_and_b32 s39, s5, 14
    s_lshl_b32 s39, s39, 6
    s_add_u32 s38, s38, s39
    s_add_u32 s45, s37, s38
    s_add_u32 s49, s38, 1572864
    s_lshl_b32 s38, s5, 6
    s_add_u32 s60, s37, s38
    s_add_u32 s61, s38, 1572864
    s_mul_i32 s37, s36, 57344
    s_lshl_b32 s38, s5, 8
    s_add_u32 s46, s37, s38
    s_add_u32 s50, s38, 1835008
    s_cmp_ge_u32 s5, 14
    s_cselect_b32 s46, 0x7f000000, s46
    s_cselect_b32 s50, -1, s50
    s_lshl_b32 s53, s6, 12
    s_lshl_b32 s54, s6, 11
    s_add_u32 s54, s54, 126976
    s_mul_i32 s62, s6, 5120
    s_add_u32 s62, s62, 65536
    s_lshl_b32 s36, s4, 7
    s_lshl_b32 s37, s5, 3
    s_add_u32 s36, s36, s37
    s_lshl_b32 s37, s6, 1
    s_add_u32 s7, s36, s37
    v_and_b32 v2, 31, v1
    v_lshrrev_b32 v3, 5, v1
    v_bfe_u32 v4, v2, 1, 3
    v_xor_b32 v4, v3, v4
    v_lshlrev_b32 v4, 4, v4
    v_lshl_add_u32 v4, v2, 7, v4
    s_lshl_b32 s3, s40, 1
    s_add_u32 s36, s3, s41
    s_xor_b32 s37, s36, 1
    s_lshl_b32 s38, s4, 2
    s_add_u32 s51, s38, s36
    s_add_u32 s52, s38, s37
    s_lshl_b32 s36, s36, 12
    s_lshl_b32 s37, s37, 12
    v_add_u32 v16, s36, v4
    v_add_u32 v20, s37, v4
    v_xor_b32 v17, 32, v16
    v_xor_b32 v21, 32, v20
    v_xor_b32 v18, 64, v16
    v_xor_b32 v22, 64, v20
    v_xor_b32 v19, 96, v16
    v_xor_b32 v23, 96, v20
    v_bfe_u32 v4, v1, 2, 2
    v_lshl_add_u32 v5, v3, 3, v4
    v_lshlrev_b32 v6, 6, v5
    v_bfe_u32 v7, v1, 4, 1
    v_lshl_add_u32 v6, v7, 5, v6
    v_and_b32 v28, 3, v1
    v_lshl_add_u32 v6, v28, 3, v6
    v_add_u32 v25, 65536, v6
    v_lshlrev_b32 v6, 7, v5
    v_lshlrev_b32 v7, 1, v7
    v_lshrrev_b32 v5, 1, v28
    v_add_u32 v7, v7, v5
    v_lshrrev_b32 v4, 1, v4
    v_lshlrev_b32 v4, 2, v4
    v_xor_b32 v7, v7, v4
    v_lshl_add_u32 v6, v7, 4, v6
    v_and_b32 v28, 1, v28
    v_lshl_add_u32 v6, v28, 3, v6
    s_lshl_b32 s36, s41, 6
    v_xor_b32 v7, s36, v6
    v_add_u32 v24, 126976, v7
    s_lshl_b32 s36, s41, 11
    s_add_u32 s36, s36, 66560
    v_add_u32 v26, s36, v6
    v_xor_b32 v7, 64, v6
    v_add_u32 v27, s36, v7
    v_bfe_u32 v4, v1, 3, 2
    v_cmp_eq_u32 vcc, 0, v4
    v_mov_b32 v5, 0x3f803f80
    s_nop 0
    v_cndmask_b32 v84, 0, v5, vcc
    v_mov_b32 v85, v84
    v_mov_b32 v86, v84
    v_mov_b32 v87, v84
    v_cmp_eq_u32 vcc, 1, v4
    v_mov_b32 v5, 0x3f803f80
    s_nop 0
    v_cndmask_b32 v88, 0, v5, vcc
    v_mov_b32 v89, v88
    v_mov_b32 v90, v88
    v_mov_b32 v91, v88
    v_cmp_eq_u32 vcc, 2, v4
    v_mov_b32 v5, 0x3f803f80
    s_nop 0
    v_cndmask_b32 v92, 0, v5, vcc
    v_mov_b32 v93, v92
    v_mov_b32 v94, v92
    v_mov_b32 v95, v92
    s_waitcnt lgkmcnt(0)
    s_load_dword s47, s[80:81], 0xf000
    s_mov_b32 s8, s64
    s_and_b32 s9, s65, 0xffff
    s_mov_b32 s10, 0x200000
    s_mov_b32 s11, 0x20000
    s_mov_b32 s12, s66
    s_and_b32 s13, s67, 0xffff
    s_mov_b32 s14, 0x180000
    s_mov_b32 s15, 0x20000
    s_lshl_b32 s36, s7, 10
    s_add_u32 s37, s36, 1024
    v_lshlrev_b32 v2, 4, v1
    buffer_load_dwordx4 v[44:47], v2, s[8:11], s36 offen
    buffer_load_dwordx4 v[48:51], v2, s[8:11], s37 offen
    s_add_u32 m0, s53, 0
    s_nop 0
    buffer_load_dwordx4 v8, s[8:11], s43 offen lds
    s_addk_i32 m0, 1024
    s_nop 0
    buffer_load_dwordx4 v9, s[8:11], s43 offen lds
    s_addk_i32 m0, 1024
    s_nop 0
    buffer_load_dwordx4 v10, s[8:11], s43 offen lds
    s_addk_i32 m0, 1024
    s_nop 0
    buffer_load_dwordx4 v11, s[8:11], s43 offen lds
    s_add_u32 s43, s43, 128
    s_cmp_ge_u32 s43, s48
    s_cselect_b32 s3, 1024, 0
    s_sub_u32 s43, s43, s3
    s_add_u32 m0, s54, 0
    s_nop 0
    buffer_load_dwordx4 v12, s[12:15], s45 offen lds
    s_addk_i32 m0, 1024
    s_nop 0
    buffer_load_dwordx4 v13, s[12:15], s45 offen lds
    s_add_u32 s45, s45, 196608
    s_cmp_ge_u32 s45, s49
    s_cselect_b32 s3, 1572864, 0
    s_sub_u32 s45, s45, s3
    s_mov_b32 s32, s80
    s_and_b32 s33, s81, 0xffff
    s_mov_b32 s34, 0x1400000
    s_mov_b32 s35, 0x20000
    s_mov_b32 s100, 0x7f000000
    s_mov_b32 s20, s72
    s_and_b32 s21, s73, 0xffff
    s_mov_b32 s22, 0x1c0000
    s_mov_b32 s23, 0x20000
    s_mov_b32 s16, s68
    s_and_b32 s17, s69, 0xffff
    s_mov_b32 s18, 0x80000
    s_mov_b32 s19, 0x20000
    s_mov_b32 s24, s74
    s_and_b32 s25, s75, 0xffff
    s_mov_b32 s26, 0x1c0000
    s_mov_b32 s27, 0x20000
    s_mov_b32 s28, s76
    s_and_b32 s29, s77, 0xffff
    s_mov_b32 s30, 0x200000
    s_mov_b32 s31, 0x20000
    s_add_u32 m0, s53, 16384
    s_nop 0
    buffer_load_dwordx4 v8, s[8:11], s43 offen lds
    s_addk_i32 m0, 1024
    s_nop 0
    buffer_load_dwordx4 v9, s[8:11], s43 offen lds
    s_addk_i32 m0, 1024
    s_nop 0
    buffer_load_dwordx4 v10, s[8:11], s43 offen lds
    s_addk_i32 m0, 1024
    s_nop 0
    buffer_load_dwordx4 v11, s[8:11], s43 offen lds
    s_add_u32 s43, s43, 128
    s_cmp_ge_u32 s43, s48
    s_cselect_b32 s3, 1024, 0
    s_sub_u32 s43, s43, s3
    s_waitcnt vmcnt(10)
    v_lshlrev_b32 v96, 16, v44
    v_and_b32 v97, 0xffff0000, v44
    v_lshlrev_b32 v98, 16, v45
    v_and_b32 v99, 0xffff0000, v45
    v_lshlrev_b32 v100, 16, v46
    v_and_b32 v101, 0xffff0000, v46
    v_lshlrev_b32 v102, 16, v47
    s_add_u32 m0, s54, 8192
    s_nop 0
    buffer_load_dwordx4 v12, s[12:15], s45 offen lds
    v_and_b32 v103, 0xffff0000, v47
    v_lshlrev_b32 v104, 16, v48
    v_and_b32 v105, 0xffff0000, v48
    v_lshlrev_b32 v106, 16, v49
    v_and_b32 v107, 0xffff0000, v49
    v_lshlrev_b32 v108, 16, v50
    v_and_b32 v109, 0xffff0000, v50
    v_lshlrev_b32 v110, 16, v51
    s_addk_i32 m0, 1024
    s_nop 0
    buffer_load_dwordx4 v13, s[12:15], s45 offen lds
    s_add_u32 s45, s45, 196608
    s_cmp_ge_u32 s45, s49
    s_cselect_b32 s3, 1572864, 0
    s_sub_u32 s45, s45, s3
    v_and_b32 v111, 0xffff0000, v51
    v_add_f32 v112, v96, v97
    v_add_f32 v113, v104, v105
    v_add_f32 v112, v112, v98
    v_add_f32 v113, v113, v106
    v_add_f32 v112, v112, v99
    v_add_f32 v113, v113, v107
    v_add_f32 v112, v112, v100
    s_add_u32 m0, s53, 32768
    s_nop 0
    buffer_load_dwordx4 v8, s[8:11], s43 offen lds
    v_add_f32 v113, v113, v108
    v_add_f32 v112, v112, v101
    v_add_f32 v113, v113, v109
    v_add_f32 v112, v112, v102
    v_add_f32 v113, v113, v110
    v_add_f32 v112, v112, v103
    v_add_f32 v113, v113, v111
    s_nop 0
    v_add_f32_dpp v112, v112, v112 quad_perm:[1,0,3,2] row_mask:0xf bank_mask:0xf
    s_addk_i32 m0, 1024
    s_nop 0
    buffer_load_dwordx4 v9, s[8:11], s43 offen lds
    v_add_f32_dpp v113, v113, v113 quad_perm:[1,0,3,2] row_mask:0xf bank_mask:0xf
    v_add_f32_dpp v112, v112, v112 quad_perm:[2,3,0,1] row_mask:0xf bank_mask:0xf
    s_nop 0
    v_add_f32_dpp v113, v113, v113 quad_perm:[2,3,0,1] row_mask:0xf bank_mask:0xf
    s_nop 0
    v_add_f32_dpp v112, v112, v112 row_half_mirror row_mask:0xf bank_mask:0xf
    s_nop 0
    v_add_f32_dpp v113, v113, v113 row_half_mirror row_mask:0xf bank_mask:0xf
    s_nop 0
    v_add_f32_dpp v112, v112, v112 row_mirror row_mask:0xf bank_mask:0xf
    s_nop 0
    v_add_f32_dpp v113, v113, v113 row_mirror row_mask:0xf bank_mask:0xf
    v_mov_b32 v114, v112
    s_addk_i32 m0, 1024
    s_nop 0
    buffer_load_dwordx4 v10, s[8:11], s43 offen lds
    v_mov_b32 v115, v113
    v_permlane16_swap_b32 v114, v112
    s_nop 0
    v_permlane16_swap_b32 v115, v113
    v_add_f32 v112, v112, v114
    v_add_f32 v113, v113, v115
    v_mov_b32 v114, v112
    v_mov_b32 v115, v113
    s_nop 0
    v_permlane32_swap_b32 v114, v112
    s_addk_i32 m0, 1024
    s_nop 0
    buffer_load_dwordx4 v11, s[8:11], s43 offen lds
    s_add_u32 s43, s43, 128
    s_cmp_ge_u32 s43, s48
    s_cselect_b32 s3, 1024, 0
    s_sub_u32 s43, s43, s3
    v_permlane32_swap_b32 v115, v113
    v_add_f32 v112, v112, v114
    v_add_f32 v113, v113, v115
    v_mul_f32 v112, 0x3b000000, v112
    v_mul_f32 v113, 0x3b000000, v113
    v_sub_f32 v96, v96, v112
    v_sub_f32 v104, v104, v113
    v_sub_f32 v97, v97, v112
    s_add_u32 m0, s54, 16384
    s_nop 0
    buffer_load_dwordx4 v12, s[12:15], s45 offen lds
    v_sub_f32 v105, v105, v113
    v_sub_f32 v98, v98, v112
    v_sub_f32 v106, v106, v113
    v_sub_f32 v99, v99, v112
    v_sub_f32 v107, v107, v113
    v_sub_f32 v100, v100, v112
    v_sub_f32 v108, v108, v113
    v_sub_f32 v101, v101, v112
    s_addk_i32 m0, 1024
    s_nop 0
    buffer_load_dwordx4 v13, s[12:15], s45 offen lds
    s_add_u32 s45, s45, 196608
    s_cmp_ge_u32 s45, s49
    s_cselect_b32 s3, 1572864, 0
    s_sub_u32 s45, s45, s3
    v_sub_f32 v109, v109, v113
    v_sub_f32 v102, v102, v112
    v_sub_f32 v110, v110, v113
    v_sub_f32 v103, v103, v112
    v_sub_f32 v111, v111, v113
    v_mul_f32 v116, v96, v96
    v_mul_f32 v117, v104, v104
    v_fmac_f32 v116, v97, v97
    s_add_u32 m0, s53, 49152
    s_nop 0
    buffer_load_dwordx4 v8, s[8:11], s43 offen lds
    v_fmac_f32 v117, v105, v105
    v_fmac_f32 v116, v98, v98
    v_fmac_f32 v117, v106, v106
    v_fmac_f32 v116, v99, v99
    v_fmac_f32 v117, v107, v107
    v_fmac_f32 v116, v100, v100
    v_fmac_f32 v117, v108, v108
    v_fmac_f32 v116, v101, v101
    s_addk_i32 m0, 1024
    s_nop 0
    buffer_load_dwordx4 v9, s[8:11], s43 offen lds
    v_fmac_f32 v117, v109, v109
    v_fmac_f32 v116, v102, v102
    v_fmac_f32 v117, v110, v110
    v_fmac_f32 v116, v103, v103
    v_fmac_f32 v117, v111, v111
    s_nop 0
    v_add_f32_dpp v116, v116, v116 quad_perm:[1,0,3,2] row_mask:0xf bank_mask:0xf
    s_nop 0
    v_add_f32_dpp v117, v117, v117 quad_perm:[1,0,3,2] row_mask:0xf bank_mask:0xf
    s_nop 0
    v_add_f32_dpp v116, v116, v116 quad_perm:[2,3,0,1] row_mask:0xf bank_mask:0xf
    s_addk_i32 m0, 1024
    s_nop 0
    buffer_load_dwordx4 v10, s[8:11], s43 offen lds
    v_add_f32_dpp v117, v117, v117 quad_perm:[2,3,0,1] row_mask:0xf bank_mask:0xf
    v_add_f32_dpp v116, v116, v116 row_half_mirror row_mask:0xf bank_mask:0xf
    s_nop 0
    v_add_f32_dpp v117, v117, v117 row_half_mirror row_mask:0xf bank_mask:0xf
    s_nop 0
    v_add_f32_dpp v116, v116, v116 row_mirror row_mask:0xf bank_mask:0xf
    s_nop 0
    v_add_f32_dpp v117, v117, v117 row_mirror row_mask:0xf bank_mask:0xf
    v_mov_b32 v114, v116
    v_mov_b32 v115, v117
    s_nop 0
    v_permlane16_swap_b32 v114, v116
    s_addk_i32 m0, 1024
    s_nop 0
    buffer_load_dwordx4 v11, s[8:11], s43 offen lds
    s_add_u32 s43, s43, 128
    s_cmp_ge_u32 s43, s48
    s_cselect_b32 s3, 1024, 0
    s_sub_u32 s43, s43, s3
    v_permlane16_swap_b32 v115, v117
    v_add_f32 v116, v116, v114
    v_add_f32 v117, v117, v115
    v_mov_b32 v114, v116
    v_mov_b32 v115, v117
    s_nop 0
    v_permlane32_swap_b32 v114, v116
    s_nop 0
    v_permlane32_swap_b32 v115, v117
    v_add_f32 v116, v116, v114
    s_add_u32 m0, s54, 24576
    s_nop 0
    buffer_load_dwordx4 v12, s[12:15], s45 offen lds
    v_add_f32 v117, v117, v115
    v_mov_b32 v114, 0x3727c5ac
    v_fmac_f32 v114, 0x3b000000, v116
    v_mov_b32 v115, 0x3727c5ac
    v_fmac_f32 v115, 0x3b000000, v117
    v_rsq_f32 v114, v114
    v_rsq_f32 v115, v115
    s_addk_i32 m0, 1024
    s_nop 0
    buffer_load_dwordx4 v13, s[12:15], s45 offen lds
    s_add_u32 s45, s45, 196608
    s_cmp_ge_u32 s45, s49
    s_cselect_b32 s3, 1572864, 0
    s_sub_u32 s45, s45, s3
    s_lshl_b32 s36, s6, 8
    s_add_u32 s36, s36, s2
    s_and_b32 s37, s36, 7
    s_lshr_b32 s38, s36, 6
    s_mul_i32 s39, s37, 10
    s_add_u32 s39, s39, s38
    s_lshl_b32 s39, s39, 3
    s_bfe_u32 s3, s36, 0x30003
    s_add_u32 s39, s39, s3
    s_lshl_b32 s39, s39, 11
    s_add_u32 s101, s39, 18874368
    s_lshr_b32 s39, s3, 2
    s_and_b32 s3, s3, 3
    s_lshl_b32 s3, s3, 4
    s_cmp_lt_u32 s38, 6
    s_cselect_b32 s56, s24, s16
    s_cselect_b32 s57, s25, s17
    s_cselect_b32 s58, s26, s18
    s_cselect_b32 s59, 7, 2
    s_cselect_b32 s78, 8, -6
    s_add_u32 s38, s38, s78
    s_mul_i32 s39, s39, s59
    s_lshl_b32 s39, s39, 7
    s_lshl_b32 s38, s38, 6
    s_add_u32 s39, s39, s38
    s_add_u32 s39, s39, s3
    s_lshl_b32 s39, s39, 10
    s_lshl_b32 s37, s37, 7
    s_add_u32 s39, s39, s37
    s_mov_b32 s59, 0x20000
    s_cmp_lt_u32 s36, 640
    s_cselect_b32 s39, s39, s100
    s_cselect_b32 s101, s101, s100
    s_lshl_b32 s38, s6, 11
    s_add_u32 m0, s38, 106496
    s_add_u32 s37, s39, 8192
    buffer_load_dwordx4 v252, s[56:59], s39 offen lds
    s_addk_i32 m0, 1024
    s_nop 0
    buffer_load_dwordx4 v252, s[56:59], s37 offen lds
    s_waitcnt lgkmcnt(0)
    s_add_u32 s47, s47, 1
    v_cmp_eq_u32_e64 s[76:77], 1, v1
    v_mov_b32 v122, s47
    v_mov_b32 v123, 0
    v_cndmask_b32 v120, v112, v113, s[76:77]
    v_cndmask_b32 v121, v114, v115, s[76:77]
    v_lshlrev_b32 v118, 4, v1
    s_lshl_b32 s80, s7, 4
    s_mov_b64 exec, 3
    buffer_store_dwordx4 v[120:123], v118, s[32:35], s80 offen offset:0 sc1
    s_mov_b64 exec, -1
    s_waitcnt vmcnt(21)
    s_barrier
    ds_read_b128 a[0:3], v16 offset:0
    ds_read_b64_tr_b16 v[32:33], v24 offset:0
    ds_read_b128 a[128:131], v20 offset:0
    ds_read_b64_tr_b16 v[34:35], v24 offset:512
    ds_read_b128 a[4:7], v17 offset:0
    ds_read_b64_tr_b16 v[36:37], v24 offset:2048
    ds_read_b128 a[132:135], v21 offset:0
    ds_read_b64_tr_b16 v[38:39], v24 offset:2560
    s_waitcnt lgkmcnt(4)
    v_mfma_f32_32x32x16_bf16 v[128:143], v[32:35], a[0:3], 0
    ds_read_b128 a[8:11], v18 offset:0
    ds_read_b64_tr_b16 v[40:41], v24 offset:4096
    v_mfma_f32_32x32x16_bf16 v[144:159], v[32:35], a[128:131], 0
    ds_read_b128 a[136:139], v22 offset:0
    ds_read_b64_tr_b16 v[42:43], v24 offset:4608
    s_bitcmp0_b32 s4, 0
    s_cbranch_scc0 L_csa0
    v_mfma_f32_32x32x16_bf16 v[68:83], v[84:87], v[32:35], 0
L_csa0:
    s_waitcnt lgkmcnt(4)
    v_mfma_f32_32x32x16_bf16 v[128:143], v[36:39], a[4:7], v[128:143]
    ds_read_b128 a[12:15], v19 offset:0
    ds_read_b64_tr_b16 v[32:33], v24 offset:6144
    v_mfma_f32_32x32x16_bf16 v[144:159], v[36:39], a[132:135], v[144:159]
    ds_read_b128 a[140:143], v23 offset:0
    ds_read_b64_tr_b16 v[34:35], v24 offset:6656
    s_bitcmp0_b32 s4, 0
    s_cbranch_scc0 L_csa1
    v_mfma_f32_32x32x16_bf16 v[68:83], v[84:87], v[36:39], v[68:83]
L_csa1:
    s_waitcnt lgkmcnt(4)
    v_mfma_f32_32x32x16_bf16 v[128:143], v[40:43], a[8:11], v[128:143]
    s_waitcnt vmcnt(15) lgkmcnt(0)
    s_barrier
    s_add_u32 m0, s53, 0
    ds_read_b128 a[16:19], v16 offset:16384
    ds_read_b64_tr_b16 v[36:37], v24 offset:8192
    buffer_load_dwordx4 v8, s[8:11], s43 offen lds
    v_mfma_f32_32x32x16_bf16 v[144:159], v[40:43], a[136:139], v[144:159]
    s_addk_i32 m0, 1024
    ds_read_b128 a[144:147], v20 offset:16384
    ds_read_b64_tr_b16 v[38:39], v24 offset:8704
    buffer_load_dwordx4 v9, s[8:11], s43 offen lds
    s_bitcmp1_b32 s4, 0
    s_cbranch_scc0 L_csa2
    v_mfma_f32_32x32x16_bf16 v[68:83], v[84:87], v[40:43], 0
L_csa2:
    s_waitcnt lgkmcnt(4)
    v_mfma_f32_32x32x16_bf16 v[128:143], v[32:35], a[12:15], v[128:143]
    s_addk_i32 m0, 1024
    ds_read_b128 a[20:23], v17 offset:16384
    ds_read_b64_tr_b16 v[40:41], v24 offset:10240
    buffer_load_dwordx4 v10, s[8:11], s43 offen lds
    v_mfma_f32_32x32x16_bf16 v[144:159], v[32:35], a[140:143], v[144:159]
    s_addk_i32 m0, 1024
    ds_read_b128 a[148:151], v21 offset:16384
    ds_read_b64_tr_b16 v[42:43], v24 offset:10752
    buffer_load_dwordx4 v11, s[8:11], s43 offen lds
    s_add_u32 s43, s43, 128
    s_cmp_ge_u32 s43, s48
    s_cselect_b32 s3, 1024, 0
    s_sub_u32 s43, s43, s3
    s_bitcmp1_b32 s4, 0
    s_cbranch_scc0 L_csa3
    v_mfma_f32_32x32x16_bf16 v[68:83], v[84:87], v[32:35], v[68:83]
L_csa3:
    s_waitcnt lgkmcnt(4)
    v_mfma_f32_32x32x16_bf16 v[128:143], v[36:39], a[16:19], v[128:143]
    s_add_u32 m0, s54, 0
    ds_read_b128 a[24:27], v18 offset:16384
    ds_read_b64_tr_b16 v[32:33], v24 offset:12288
    buffer_load_dwordx4 v12, s[12:15], s45 offen lds
    s_lshl_b32 s81, s5, 1
    s_add_u32 s81, s81, s41
    s_lshl_b32 s81, s81, 3
    s_lshr_b32 s79, s4, 1
    v_mfma_f32_32x32x16_bf16 v[144:159], v[36:39], a[144:147], v[144:159]
    s_addk_i32 m0, 1024
    ds_read_b128 a[152:155], v22 offset:16384
    ds_read_b64_tr_b16 v[34:35], v24 offset:12800
    buffer_load_dwordx4 v13, s[12:15], s45 offen lds
    s_add_u32 s45, s45, 196608
    s_cmp_ge_u32 s45, s49
    s_cselect_b32 s3, 1572864, 0
    s_sub_u32 s45, s45, s3
    s_add_u32 s81, s81, s79
    s_lshl_b32 s81, s81, 9
    s_and_b32 s79, s4, 1
    s_lshl_b32 s79, s79, 3
    s_waitcnt lgkmcnt(4)
    v_mfma_f32_32x32x16_bf16 v[128:143], v[40:43], a[20:23], v[128:143]
    ds_read_b128 a[28:31], v19 offset:16384
    ds_read_b64_tr_b16 v[36:37], v24 offset:14336
    s_add_u32 s81, s81, s79
    s_add_u32 s81, s81, 65536
    s_cmp_eq_u32 s40, 0
    s_cselect_b32 s81, s81, s100
    v_mfma_f32_32x32x16_bf16 v[144:159], v[40:43], a[148:151], v[144:159]
    ds_read_b128 a[156:159], v23 offset:16384
    ds_read_b64_tr_b16 v[38:39], v24 offset:14848
    v_and_b32 v119, 31, v1
    v_lshlrev_b32 v119, 4, v119
    v_mov_b32 v69, s47
    buffer_store_dwordx2 v[68:69], v119, s[32:35], s81 offen sc1
    s_waitcnt lgkmcnt(4)
    v_mfma_f32_32x32x16_bf16 v[128:143], v[32:35], a[24:27], v[128:143]
    s_waitcnt vmcnt(16) lgkmcnt(0)
    s_barrier
    s_add_u32 m0, s53, 16384
    ds_read_b128 a[32:35], v16 offset:32768
    ds_read_b64_tr_b16 v[40:41], v24 offset:16384
    buffer_load_dwordx4 v8, s[8:11], s43 offen lds
    s_and_b32 s64, s6, 1
    s_lshr_b32 s65, s6, 1
    s_and_b32 s78, s2, 7
    s_lshl_b32 s78, s78, 2
    v_mfma_f32_32x32x16_bf16 v[144:159], v[32:35], a[152:155], v[144:159]
    s_addk_i32 m0, 1024
    ds_read_b128 a[160:163], v20 offset:32768
    ds_read_b64_tr_b16 v[42:43], v24 offset:16896
    buffer_load_dwordx4 v9, s[8:11], s43 offen lds
    s_lshr_b32 s79, s99, 3
    s_add_u32 s78, s78, s79
    s_lshr_b32 s98, s78, 1
    s_lshl_b32 s78, s78, 1
    s_waitcnt lgkmcnt(4)
    v_mfma_f32_32x32x16_bf16 v[128:143], v[36:39], a[28:31], v[128:143]
    s_addk_i32 m0, 1024
    ds_read_b128 a[36:39], v17 offset:32768
    ds_read_b64_tr_b16 v[32:33], v24 offset:18432
    buffer_load_dwordx4 v10, s[8:11], s43 offen lds
    s_add_u32 s66, s78, s64
    s_add_u32 s67, s99, 0
    s_and_b32 s67, s67, 7
    v_lshlrev_b32 v253, 4, v1
    v_mfma_f32_32x32x16_bf16 v[144:159], v[36:39], a[156:159], v[144:159]
    s_addk_i32 m0, 1024
    ds_read_b128 a[164:167], v21 offset:32768
    ds_read_b64_tr_b16 v[34:35], v24 offset:18944
    buffer_load_dwordx4 v11, s[8:11], s43 offen lds
    s_add_u32 s43, s43, 128
    s_cmp_ge_u32 s43, s48
    s_cselect_b32 s3, 1024, 0
    s_sub_u32 s43, s43, s3
    v_bfe_u32 v112, v1, 2, 2
    v_lshrrev_b32 v113, 5, v1
    v_lshl_add_u32 v113, v113, 2, v112
    v_lshlrev_b32 v113, 7, v113
    s_waitcnt lgkmcnt(4)
    v_mfma_f32_32x32x16_bf16 v[128:143], v[40:43], a[32:35], v[128:143]
    s_add_u32 m0, s54, 8192
    ds_read_b128 a[40:43], v18 offset:32768
    ds_read_b64_tr_b16 v[36:37], v24 offset:20480
    buffer_load_dwordx4 v12, s[12:15], s45 offen lds
    v_bfe_u32 v114, v1, 4, 1
    v_lshlrev_b32 v114, 1, v114
    v_bfe_u32 v115, v1, 1, 1
    v_add_u32 v114, v114, v115
    v_mfma_f32_32x32x16_bf16 v[144:159], v[40:43], a[160:163], v[144:159]
    s_addk_i32 m0, 1024
    ds_read_b128 a[168:171], v22 offset:32768
    ds_read_b64_tr_b16 v[38:39], v24 offset:20992
    buffer_load_dwordx4 v13, s[12:15], s45 offen lds
    s_add_u32 s45, s45, 196608
    s_cmp_ge_u32 s45, s49
    s_cselect_b32 s3, 1572864, 0
    s_sub_u32 s45, s45, s3
    v_lshrrev_b32 v112, 1, v112
    v_lshlrev_b32 v112, 2, v112
    v_xor_b32 v114, v114, v112
    v_lshl_add_u32 v113, v114, 4, v113
    s_waitcnt lgkmcnt(4)
    v_mfma_f32_32x32x16_bf16 v[128:143], v[32:35], a[36:39], v[128:143]
    ds_read_b128 a[44:47], v19 offset:32768
    ds_read_b64_tr_b16 v[40:41], v24 offset:22528
    v_and_b32 v114, 1, v1
    v_lshl_add_u32 v113, v114, 3, v113
    s_mul_i32 s78, s65, 8192
    v_add_u32 v254, s78, v113
    v_mfma_f32_32x32x16_bf16 v[144:159], v[32:35], a[164:167], v[144:159]
    ds_read_b128 a[172:175], v23 offset:32768
    ds_read_b64_tr_b16 v[42:43], v24 offset:23040
    s_add_u32 s78, s67, 0
    s_and_b32 s78, s78, 7
    s_lshl_b32 s78, s78, 7
    s_lshl_b32 s79, s64, 13
    s_waitcnt lgkmcnt(4)
    v_mfma_f32_32x32x16_bf16 v[128:143], v[36:39], a[40:43], v[128:143]
    s_waitcnt vmcnt(16) lgkmcnt(0)
    s_barrier
    s_add_u32 m0, s53, 32768
    ds_read_b128 a[48:51], v16 offset:49152
    ds_read_b64_tr_b16 v[32:33], v24 offset:24576
    buffer_load_dwordx4 v8, s[8:11], s43 offen lds
    s_add_u32 s78, s78, s79
    s_mul_i32 s79, s65, 917504
    s_add_u32 s68, s78, s79
    s_mul_i32 s78, s67, 163840
    v_mfma_f32_32x32x16_bf16 v[144:159], v[36:39], a[168:171], v[144:159]
    s_addk_i32 m0, 1024
    ds_read_b128 a[176:179], v20 offset:49152
    ds_read_b64_tr_b16 v[34:35], v24 offset:25088
    buffer_load_dwordx4 v9, s[8:11], s43 offen lds
    s_lshl_b32 s79, s6, 12
    s_add_u32 s78, s78, s79
    s_add_u32 s69, s78, 18857984
    s_mul_i32 s78, s66, 114688
    s_waitcnt lgkmcnt(4)
    v_mfma_f32_32x32x16_bf16 v[128:143], v[40:43], a[44:47], v[128:143]
    s_addk_i32 m0, 1024
    ds_read_b128 a[52:55], v17 offset:49152
    ds_read_b64_tr_b16 v[36:37], v24 offset:26624
    buffer_load_dwordx4 v10, s[8:11], s43 offen lds
    s_mul_i32 s79, s65, 57344
    s_add_u32 s78, s78, s79
    s_add_u32 s70, s78, 9437184
    s_lshl_b32 s78, s66, 15
    v_mfma_f32_32x32x16_bf16 v[144:159], v[40:43], a[172:175], v[144:159]
    s_addk_i32 m0, 1024
    ds_read_b128 a[180:183], v21 offset:49152
    ds_read_b64_tr_b16 v[38:39], v24 offset:27136
    buffer_load_dwordx4 v11, s[8:11], s43 offen lds
    s_add_u32 s43, s43, 128
    s_cmp_ge_u32 s43, s48
    s_cselect_b32 s3, 1024, 0
    s_sub_u32 s43, s43, s3
    s_lshl_b32 s79, s65, 14
    s_add_u32 s78, s78, s79
    s_add_u32 s71, s78, 7340032
    s_mul_i32 s78, s65, 8192
    s_waitcnt lgkmcnt(4)
    v_mfma_f32_32x32x16_bf16 v[128:143], v[32:35], a[48:51], v[128:143]
    s_add_u32 m0, s54, 16384
    ds_read_b128 a[56:59], v18 offset:49152
    ds_read_b64_tr_b16 v[40:41], v24 offset:28672
    buffer_load_dwordx4 v12, s[12:15], s45 offen lds
    s_lshl_b32 s79, s64, 10
    s_add_u32 s72, s78, s79
    s_lshl_b32 s74, s4, 2
    s_add_u32 s74, s74, s6
    v_mfma_f32_32x32x16_bf16 v[144:159], v[32:35], a[176:179], v[144:159]
    s_addk_i32 m0, 1024
    ds_read_b128 a[184:187], v22 offset:49152
    ds_read_b64_tr_b16 v[42:43], v24 offset:29184
    buffer_load_dwordx4 v13, s[12:15], s45 offen lds
    s_add_u32 s45, s45, 196608
    s_cmp_ge_u32 s45, s49
    s_cselect_b32 s3, 1572864, 0
    s_sub_u32 s45, s45, s3
    s_waitcnt vmcnt(20)
    s_lshl_b32 s78, s6, 11
    s_add_u32 s78, s78, 106496
    s_lshl_b32 s79, s65, 13
    s_waitcnt lgkmcnt(4)
    v_mfma_f32_32x32x16_bf16 v[128:143], v[36:39], a[52:55], v[128:143]
    ds_read_b128 a[60:63], v19 offset:49152
    ds_read_b64_tr_b16 v[32:33], v24 offset:30720
    s_sub_u32 s78, s78, s79
    v_add_u32 v52, s78, v254
    v_xor_b32 v53, 64, v52
    ds_read_b64_tr_b16 v[44:45], v52 offset:0
    v_mfma_f32_32x32x16_bf16 v[144:159], v[36:39], a[180:183], v[144:159]
    ds_read_b128 a[188:191], v23 offset:49152
    ds_read_b64_tr_b16 v[34:35], v24 offset:31232
    ds_read_b64_tr_b16 v[46:47], v52 offset:1024
    ds_read_b64_tr_b16 v[48:49], v53 offset:0
    ds_read_b64_tr_b16 v[50:51], v53 offset:1024
    v_and_b32 v112, 31, v1
    s_waitcnt lgkmcnt(4)
    v_mfma_f32_32x32x16_bf16 v[128:143], v[40:43], a[56:59], v[128:143]
    s_waitcnt vmcnt(13) lgkmcnt(0)
    s_barrier
    s_add_u32 m0, s53, 49152
    ds_read_b128 a[64:67], v16 offset:0
    ds_read_b64_tr_b16 v[36:37], v24 offset:0
    buffer_load_dwordx4 v8, s[8:11], s43 offen lds
    v_lshrrev_b32 v113, 5, v1
    v_lshlrev_b32 v113, 2, v113
    v_sub_u32 v112, v112, v113
    v_add_u32 v112, 1, v112
    v_mfma_f32_32x32x16_bf16 v[144:159], v[40:43], a[184:187], v[144:159]
    s_addk_i32 m0, 1024
    ds_read_b128 a[192:195], v20 offset:0
    ds_read_b64_tr_b16 v[38:39], v24 offset:512
    buffer_load_dwordx4 v9, s[8:11], s43 offen lds
    v_max_i32 v114, 0, v112
    v_mov_b32 v113, -1
    v_lshlrev_b32 v113, v114, v113
    v_cmp_gt_i32_e64 s[76:77], 32, v112
    s_waitcnt lgkmcnt(4)
    v_mfma_f32_32x32x16_bf16 v[128:143], v[32:35], a[60:63], v[128:143]
    s_addk_i32 m0, 1024
    ds_read_b128 a[68:71], v17 offset:0
    ds_read_b64_tr_b16 v[40:41], v24 offset:2048
    buffer_load_dwordx4 v10, s[8:11], s43 offen lds
    v_mov_b32 v115, 0xffff
    v_cndmask_b32 v113, 0, v113, s[76:77]
    v_bfe_i32 v114, v113, 0, 1
    v_bfe_i32 v116, v113, 1, 1
    v_mfma_f32_32x32x16_bf16 v[144:159], v[32:35], a[188:191], v[144:159]
    s_addk_i32 m0, 1024
    ds_read_b128 a[196:199], v21 offset:0
    ds_read_b64_tr_b16 v[42:43], v24 offset:2560
    buffer_load_dwordx4 v11, s[8:11], s43 offen lds
    s_add_u32 s43, s43, 128
    s_cmp_ge_u32 s43, s48
    s_cselect_b32 s3, 1024, 0
    s_sub_u32 s43, s43, s3
    v_bfi_b32 v240, v115, v114, v116
    v_bfe_i32 v114, v113, 2, 1
    v_bfe_i32 v116, v113, 3, 1
    v_bfi_b32 v241, v115, v114, v116
    s_waitcnt lgkmcnt(4)
    v_mfma_f32_32x32x16_bf16 v[128:143], v[36:39], a[64:67], v[128:143]
    s_add_u32 m0, s54, 24576
    ds_read_b128 a[72:75], v18 offset:0
    ds_read_b64_tr_b16 v[32:33], v24 offset:4096
    buffer_load_dwordx4 v12, s[12:15], s45 offen lds
    v_bfe_i32 v114, v113, 8, 1
    v_bfe_i32 v116, v113, 9, 1
    v_bfi_b32 v242, v115, v114, v116
    v_mfma_f32_32x32x16_bf16 v[144:159], v[36:39], a[192:195], v[144:159]
    s_addk_i32 m0, 1024
    ds_read_b128 a[200:203], v22 offset:0
    ds_read_b64_tr_b16 v[34:35], v24 offset:4608
    buffer_load_dwordx4 v13, s[12:15], s45 offen lds
    s_add_u32 s45, s45, 196608
    s_cmp_ge_u32 s45, s49
    s_cselect_b32 s3, 1572864, 0
    s_sub_u32 s45, s45, s3
    v_bfe_i32 v114, v113, 10, 1
    v_bfe_i32 v116, v113, 11, 1
    v_bfi_b32 v243, v115, v114, v116
    buffer_store_dwordx4 v[44:47], v253, s[32:35], s101 offen sc1
    buffer_store_dwordx4 v[48:51], v253, s[32:35], s101 offen offset:1024 sc1
    s_waitcnt lgkmcnt(4)
    v_mfma_f32_32x32x16_bf16 v[128:143], v[40:43], a[68:71], v[128:143]
    s_add_u32 m0, s62, 0
    ds_read_b128 a[76:79], v19 offset:0
    ds_read_b64_tr_b16 v[36:37], v24 offset:6144
    buffer_load_dwordx4 v14, s[12:15], s60 offen lds
    s_add_u32 s60, s60, 196608
    s_cmp_ge_u32 s60, s61
    s_cselect_b32 s3, 1572864, 0
    s_sub_u32 s60, s60, s3
    v_bfe_i32 v114, v113, 16, 1
    v_bfe_i32 v116, v113, 17, 1
    v_bfi_b32 v244, v115, v114, v116
    v_mfma_f32_32x32x16_bf16 v[144:159], v[40:43], a[196:199], v[144:159]
    s_addk_i32 m0, 1024
    ds_read_b128 a[204:207], v23 offset:0
    ds_read_b64_tr_b16 v[38:39], v24 offset:6656
    buffer_load_dwordx4 v15, s[20:23], s46 offen lds
    v_bfe_i32 v114, v113, 18, 1
    v_bfe_i32 v116, v113, 19, 1
    v_bfi_b32 v245, v115, v114, v116
    s_waitcnt lgkmcnt(4)
    v_mfma_f32_32x32x16_bf16 v[128:143], v[32:35], a[72:75], v[128:143]
    s_waitcnt vmcnt(16) lgkmcnt(0)
    s_barrier
    s_addk_i32 m0, 1024
    ds_read_b128 a[80:83], v16 offset:16384
    ds_read_b64_tr_b16 v[40:41], v24 offset:8192
    buffer_load_dwordx4 v29, s[20:23], s46 offen lds
    v_bfe_i32 v114, v113, 24, 1
    v_bfe_i32 v116, v113, 25, 1
    v_bfi_b32 v246, v115, v114, v116
    v_mfma_f32_32x32x16_bf16 v[144:159], v[32:35], a[200:203], v[144:159]
    s_addk_i32 m0, 896
    ds_read_b128 a[208:211], v20 offset:16384
    ds_read_b64_tr_b16 v[42:43], v24 offset:8704
    buffer_load_dwordx4 v15, s[20:23], s46 offen offset:128 lds
    v_bfe_i32 v114, v113, 26, 1
    v_bfe_i32 v116, v113, 27, 1
    v_bfi_b32 v247, v115, v114, v116
    s_waitcnt lgkmcnt(4)
    v_mfma_f32_32x32x16_bf16 v[128:143], v[36:39], a[76:79], v[128:143]
    s_addk_i32 m0, 1024
    ds_read_b128 a[84:87], v17 offset:16384
    ds_read_b64_tr_b16 v[32:33], v24 offset:10240
    buffer_load_dwordx4 v29, s[20:23], s46 offen offset:128 lds
    s_add_u32 s46, s46, 229376
    s_cmp_ge_u32 s46, s50
    s_cselect_b32 s3, 1835008, 0
    s_sub_u32 s46, s46, s3
    v_and_b32 v112, 31, v1
    v_lshrrev_b32 v113, 5, v1
    v_bfe_u32 v114, v112, 3, 1
    v_mfma_f32_32x32x16_bf16 v[144:159], v[36:39], a[204:207], v[144:159]
    ds_read_b128 a[212:215], v21 offset:16384
    ds_read_b64_tr_b16 v[34:35], v24 offset:10752
    v_xor_b32 v113, v113, v114
    v_lshl_add_u32 v113, v112, 1, v113
    v_lshlrev_b32 v255, 4, v113
    s_waitcnt lgkmcnt(4)
    v_mfma_f32_32x32x16_bf16 v[128:143], v[40:43], a[80:83], v[128:143]
    ds_read_b128 a[88:91], v18 offset:16384
    ds_read_b64_tr_b16 v[36:37], v24 offset:12288
    s_add_u32 s78, s6, 8
    s_lshl_b32 s78, s78, 11
    s_add_u32 s79, s78, 0
    v_mfma_f32_32x32x16_bf16 v[144:159], v[40:43], a[208:211], v[144:159]
    ds_read_b128 a[216:219], v22 offset:16384
    ds_read_b64_tr_b16 v[38:39], v24 offset:12800
    v_add_u32 v248, s79, v255
    v_bfe_u32 v112, v1, 2, 2
    v_lshrrev_b32 v113, 5, v1
    v_lshl_add_u32 v112, v113, 2, v112
    v_lshlrev_b32 v112, 5, v112
    v_and_b32 v114, 1, v1
    v_lshl_add_u32 v115, v114, 4, v112
    v_bfe_u32 v116, v1, 1, 1
    v_lshl_add_u32 v115, v116, 3, v115
    v_xor_b32 v116, 16, v115
    v_add_u32 v116, 256, v116
    s_add_u32 s79, s78, 24576
    v_add_u32 v115, s79, v115
    v_add_u32 v116, s79, v116
    v_xor_b32 v113, 1, v113
    v_lshlrev_b32 v113, 7, v113
    s_add_u32 s79, s6, 8
    s_lshl_b32 s79, s79, 3
    s_add_u32 s79, s79, 159744
    v_add_u32 v113, s79, v113
    v_bfe_u32 v114, v1, 4, 1
    v_cmp_eq_u32_e64 s[76:77], 1, v114
    v_mov_b32 v117, 0xfffff800
    v_mov_b32 v114, -8
    v_cndmask_b32 v249, v115, v113, s[76:77]
    v_cndmask_b32 v250, v116, v113, s[76:77]
    v_cndmask_b32 v251, v117, v114, s[76:77]
    v_lshrrev_b32 v112, 4, v1
    v_and_b32 v113, 15, v1
    s_lshl_b32 s78, s4, 2
    v_add_u32 v114, s78, v113
    v_cmp_le_u32_e64 s[76:77], 8, v114
    v_mov_b32 v115, 0x3f803f80
    v_lshlrev_b32 v113, 3, v113
    v_and_b32 v114, 1, v112
    v_cndmask_b32 v116, 0, v115, s[76:77]
    v_lshl_add_u32 v113, v114, 7, v113
    v_lshrrev_b32 v112, 1, v112
    v_lshl_add_u32 v113, v112, 9, v113
    v_add_u32 v113, 159744, v113
    v_mov_b32 v117, v116
    ds_write_b64 v113, v[116:117]
    ds_write_b64 v113, v[116:117] offset:1024
    v_bfe_u32 v112, v1, 2, 2
    v_min_u32 v112, 2, v112
    v_sub_u32 v114, s4, v112
    v_bfe_u32 v113, v1, 1, 1
    s_and_b32 s78, s5, 14
    v_add_u32 v113, s78, v113
    v_lshl_add_u32 v113, v114, 4, v113
    v_and_b32 v115, 1, v1
    v_lshlrev_b32 v115, 1, v115
    s_and_b32 s78, s5, 1
    v_add_u32 v115, s78, v115
    v_lshl_add_u32 v113, v113, 2, v115
    v_lshlrev_b32 v113, 3, v113
    v_add_u32 v113, 17827840, v113
    v_cmp_gt_i32_e64 s[76:77], 0, v114
    v_mov_b32 v115, s100
    s_nop 0
    v_cndmask_b32 v28, v113, v115, s[76:77]
    s_lshl_b32 s58, s5, 1
    s_and_b32 s78, s6, 1
    s_add_u32 s58, s58, s78
    s_lshl_b32 s58, s58, 16
    s_lshl_b32 s59, s78, 10
    s_lshr_b32 s78, s6, 1
    s_mul_i32 s79, s78, 24576
    s_add_u32 s59, s59, s79
    s_mul_i32 s79, s78, 2097152
    s_add_u32 s58, s58, s79
    s_lshl_b32 s79, s4, 12
    s_add_u32 s58, s58, s79
    s_add_u32 s58, s58, 1040384
    s_waitcnt lgkmcnt(4)
    v_mfma_f32_32x32x16_bf16 v[128:143], v[32:35], a[84:87], v[128:143]
    ds_read_b128 a[92:95], v19 offset:16384
    ds_read_b64_tr_b16 v[40:41], v24 offset:14336
    v_and_b32 v6, 31, v1
    v_lshrrev_b32 v7, 5, v1
    s_sub_u32 s36, s52, s51
    v_mul_i32_i24 v7, s36, v7
    v_add_u32 v7, s51, v7
    v_lshl_add_u32 v6, v7, 5, v6
    v_lshlrev_b32 v6, 4, v6
    buffer_load_dwordx4 v[96:99], v6, s[32:35], 0 offen offset:0 sc1
    v_mfma_f32_32x32x16_bf16 v[144:159], v[32:35], a[212:215], v[144:159]
    ds_read_b128 a[220:223], v23 offset:16384
    ds_read_b64_tr_b16 v[42:43], v24 offset:14848
    s_lshl_b32 s36, s5, 1
    s_add_u32 s36, s36, s41
    s_lshl_b32 s36, s36, 12
    s_add_u32 s36, s36, 65536
    v_lshlrev_b32 v6, 4, v1
    buffer_load_dwordx4 v[104:107], v6, s[32:35], s36 offen offset:0 sc1
    buffer_load_dwordx4 v[108:111], v6, s[32:35], s36 offen offset:1024 sc1
    buffer_load_dwordx4 v[112:115], v6, s[32:35], s36 offen offset:2048 sc1
    buffer_load_dwordx4 v[116:119], v6, s[32:35], s36 offen offset:3072 sc1
    s_waitcnt lgkmcnt(4)
    v_mfma_f32_32x32x16_bf16 v[128:143], v[36:39], a[88:91], v[128:143]
    s_waitcnt vmcnt(18) lgkmcnt(0)
    s_barrier
    ds_read_b128 a[96:99], v16 offset:32768
    ds_read_b64_tr_b16 v[32:33], v24 offset:16384
    v_mfma_f32_32x32x16_bf16 v[144:159], v[36:39], a[216:219], v[144:159]
    ds_read_b128 a[224:227], v20 offset:32768
    ds_read_b64_tr_b16 v[34:35], v24 offset:16896
    s_waitcnt lgkmcnt(4)
    v_mfma_f32_32x32x16_bf16 v[128:143], v[40:43], a[92:95], v[128:143]
    ds_read_b128 a[100:103], v17 offset:32768
    ds_read_b64_tr_b16 v[36:37], v24 offset:18432
    v_mfma_f32_32x32x16_bf16 v[144:159], v[40:43], a[220:223], v[144:159]
    ds_read_b128 a[228:231], v21 offset:32768
    ds_read_b64_tr_b16 v[38:39], v24 offset:18944
    s_waitcnt lgkmcnt(4)
    v_mfma_f32_32x32x16_bf16 v[128:143], v[32:35], a[96:99], v[128:143]
    ds_read_b128 a[104:107], v18 offset:32768
    ds_read_b64_tr_b16 v[40:41], v24 offset:20480
    v_mfma_f32_32x32x16_bf16 v[144:159], v[32:35], a[224:227], v[144:159]
    ds_read_b128 a[232:235], v22 offset:32768
    ds_read_b64_tr_b16 v[42:43], v24 offset:20992
    s_waitcnt lgkmcnt(4)
    v_mfma_f32_32x32x16_bf16 v[128:143], v[36:39], a[100:103], v[128:143]
    ds_read_b128 a[108:111], v19 offset:32768
    ds_read_b64_tr_b16 v[32:33], v24 offset:22528
    v_mfma_f32_32x32x16_bf16 v[144:159], v[36:39], a[228:231], v[144:159]
    ds_read_b128 a[236:239], v23 offset:32768
    ds_read_b64_tr_b16 v[34:35], v24 offset:23040
    s_waitcnt lgkmcnt(4)
    v_mfma_f32_32x32x16_bf16 v[128:143], v[40:43], a[104:107], v[128:143]
    s_waitcnt vmcnt(12) lgkmcnt(0)
    s_barrier
    s_add_u32 m0, s62, 20480
    ds_read_b128 a[112:115], v16 offset:49152
    ds_read_b64_tr_b16 v[36:37], v24 offset:24576
    buffer_load_dwordx4 v14, s[12:15], s60 offen lds
    s_add_u32 s60, s60, 196608
    s_cmp_ge_u32 s60, s61
    s_cselect_b32 s3, 1572864, 0
    s_sub_u32 s60, s60, s3
    v_mfma_f32_32x32x16_bf16 v[144:159], v[40:43], a[232:235], v[144:159]
    s_addk_i32 m0, 1024
    ds_read_b128 a[240:243], v20 offset:49152
    ds_read_b64_tr_b16 v[38:39], v24 offset:25088
    buffer_load_dwordx4 v15, s[20:23], s46 offen lds
    s_waitcnt lgkmcnt(4)
    v_mfma_f32_32x32x16_bf16 v[128:143], v[32:35], a[108:111], v[128:143]
    s_addk_i32 m0, 1024
    ds_read_b128 a[116:119], v17 offset:49152
    ds_read_b64_tr_b16 v[40:41], v24 offset:26624
    buffer_load_dwordx4 v29, s[20:23], s46 offen lds
    v_mfma_f32_32x32x16_bf16 v[144:159], v[32:35], a[236:239], v[144:159]
    s_addk_i32 m0, 896
    ds_read_b128 a[244:247], v21 offset:49152
    ds_read_b64_tr_b16 v[42:43], v24 offset:27136
    buffer_load_dwordx4 v15, s[20:23], s46 offen offset:128 lds
    s_waitcnt lgkmcnt(4)
    v_mfma_f32_32x32x16_bf16 v[128:143], v[36:39], a[112:115], v[128:143]
    s_addk_i32 m0, 1024
    ds_read_b128 a[120:123], v18 offset:49152
    ds_read_b64_tr_b16 v[32:33], v24 offset:28672
    buffer_load_dwordx4 v29, s[20:23], s46 offen offset:128 lds
    s_add_u32 s46, s46, 229376
    s_cmp_ge_u32 s46, s50
    s_cselect_b32 s3, 1835008, 0
    s_sub_u32 s46, s46, s3
    v_mfma_f32_32x32x16_bf16 v[144:159], v[36:39], a[240:243], v[144:159]
    ds_read_b128 a[248:251], v22 offset:49152
    ds_read_b64_tr_b16 v[34:35], v24 offset:29184
    s_waitcnt lgkmcnt(4)
    v_mfma_f32_32x32x16_bf16 v[128:143], v[40:43], a[116:119], v[128:143]
    ds_read_b128 a[124:127], v19 offset:49152
    ds_read_b64_tr_b16 v[36:37], v24 offset:30720
    v_mfma_f32_32x32x16_bf16 v[144:159], v[40:43], a[244:247], v[144:159]
    ds_read_b128 a[252:255], v23 offset:49152
    ds_read_b64_tr_b16 v[38:39], v24 offset:31232
    s_waitcnt lgkmcnt(4)
    v_mfma_f32_32x32x16_bf16 v[128:143], v[32:35], a[120:123], v[128:143]
    s_waitcnt vmcnt(10) lgkmcnt(0)
    s_barrier
    s_add_u32 m0, s62, 40960
    s_nop 0
    buffer_load_dwordx4 v14, s[12:15], s60 offen lds
    s_add_u32 s60, s60, 196608
    s_cmp_ge_u32 s60, s61
    s_cselect_b32 s3, 1572864, 0
    s_sub_u32 s60, s60, s3
    v_mfma_f32_32x32x16_bf16 v[144:159], v[32:35], a[248:251], v[144:159]
    s_addk_i32 m0, 1024
    s_nop 0
    buffer_load_dwordx4 v15, s[20:23], s46 offen lds
    s_waitcnt lgkmcnt(0)
    v_mfma_f32_32x32x16_bf16 v[128:143], v[36:39], a[124:127], v[128:143]
    s_addk_i32 m0, 1024
    ds_read_b64_tr_b16 v[44:45], v25 offset:0
    ds_read_b64_tr_b16 v[46:47], v25 offset:256
    ds_read_b64_tr_b16 v[48:49], v26 offset:0
    buffer_load_dwordx4 v29, s[20:23], s46 offen lds
    v_mfma_f32_32x32x16_bf16 v[144:159], v[36:39], a[252:255], v[144:159]
    s_addk_i32 m0, 896
    ds_read_b64_tr_b16 v[50:51], v26 offset:512
    ds_read_b64_tr_b16 v[52:53], v27 offset:0
    ds_read_b64_tr_b16 v[54:55], v27 offset:512
    buffer_load_dwordx4 v15, s[20:23], s46 offen offset:128 lds
    s_waitcnt lgkmcnt(0)
    v_mfma_f32_32x32x16_bf16 v[160:175], v[44:47], a[0:3], 0
    ds_read_b64_tr_b16 v[56:57], v25 offset:5120
    ds_read_b64_tr_b16 v[58:59], v25 offset:5376
    v_mfma_f32_32x32x16_bf16 v[176:191], v[48:51], a[0:3], 0
    s_addk_i32 m0, 1024
    ds_read_b64_tr_b16 v[60:61], v26 offset:5120
    ds_read_b64_tr_b16 v[62:63], v26 offset:5632
    buffer_load_dwordx4 v29, s[20:23], s46 offen offset:128 lds
    s_add_u32 s46, s46, 229376
    s_cmp_ge_u32 s46, s50
    s_cselect_b32 s3, 1835008, 0
    s_sub_u32 s46, s46, s3
    v_mfma_f32_32x32x16_bf16 v[192:207], v[48:51], a[128:131], 0
    ds_read_b64_tr_b16 v[64:65], v27 offset:5120
    ds_read_b64_tr_b16 v[66:67], v27 offset:5632
    v_mfma_f32_32x32x16_bf16 v[208:223], v[52:55], a[0:3], 0
    v_mfma_f32_32x32x16_bf16 v[224:239], v[52:55], a[128:131], 0
    s_bitcmp0_b32 s4, 0
    s_cbranch_scc0 L_csb0
    v_mfma_f32_32x32x16_bf16 v[68:83], v[84:87], v[44:47], 0
    v_mfma_f32_32x32x16_bf16 v[68:83], v[88:91], v[48:51], v[68:83]
    v_mfma_f32_32x32x16_bf16 v[68:83], v[92:95], v[52:55], v[68:83]
L_csb0:
    s_waitcnt lgkmcnt(0)
    v_mfma_f32_32x32x16_bf16 v[160:175], v[56:59], a[4:7], v[160:175]
    ds_read_b64_tr_b16 v[44:45], v25 offset:10240
    ds_read_b64_tr_b16 v[46:47], v25 offset:10496
    s_waitcnt vmcnt(10)
    v_min3_u32 v2, v98, v105, v107
    v_max3_u32 v3, v98, v105, v107
    v_min3_u32 v2, v2, v109, v111
    v_max3_u32 v3, v3, v109, v111
    v_min3_u32 v2, v2, v113, v115
    v_max3_u32 v3, v3, v113, v115
    v_min3_u32 v2, v2, v117, v119
    v_max3_u32 v3, v3, v117, v119
    v_xor_b32 v2, s47, v2
    v_xor_b32 v3, s47, v3
    v_or_b32 v2, v2, v3
    v_cmp_eq_u32 vcc, 0, v2
    s_nop 0
    s_cmp_eq_u64 vcc, -1
    s_cbranch_scc0 L_ga_spin
L_ga_ok:
    v_mfma_f32_32x32x16_bf16 v[176:191], v[60:63], a[4:7], v[176:191]
    ds_read_b64_tr_b16 v[48:49], v26 offset:10240
    ds_read_b64_tr_b16 v[50:51], v26 offset:10752
    v_add_f32 v104, v104, v106
    v_add_f32 v104, v104, v108
    v_add_f32 v104, v104, v110
    v_add_f32 v104, v104, v112
    v_add_f32 v104, v104, v114
    v_mfma_f32_32x32x16_bf16 v[192:207], v[60:63], a[132:135], v[192:207]
    ds_read_b64_tr_b16 v[52:53], v27 offset:10240
    ds_read_b64_tr_b16 v[54:55], v27 offset:10752
    v_add_f32 v104, v104, v116
    v_add_f32 v104, v104, v118
    v_cmp_gt_u32_e64 s[76:77], 32, v1
    v_mov_b32 v105, v104
    s_nop 1
    v_permlane32_swap_b32 v105, v104
    v_mfma_f32_32x32x16_bf16 v[208:223], v[64:67], a[4:7], v[208:223]
    v_add_f32 v104, v104, v105
    v_mov_b32 v100, v96
    v_mov_b32 v101, v97
    s_nop 0
    v_permlane32_swap_b32 v96, v100
    s_nop 0
    v_permlane32_swap_b32 v97, v101
    v_cvt_pk_bf16_f32 v32, -v96, -v96
    v_lshlrev_b32 v7, 16, v32
    v_mfma_f32_32x32x16_bf16 v[224:239], v[64:67], a[132:135], v[224:239]
    v_sub_f32_e64 v7, -v96, v7
    v_cvt_pk_bf16_f32 v33, v7, 0
    v_cndmask_b32 v32, 0, v32, s[76:77]
    v_cndmask_b32 v33, 0, v33, s[76:77]
    v_mov_b32 v34, 0
    v_mov_b32 v35, 0
    v_cvt_pk_bf16_f32 v36, -v100, -v100
    s_bitcmp0_b32 s4, 0
    s_cbranch_scc0 L_csb1
    v_mfma_f32_32x32x16_bf16 v[68:83], v[84:87], v[56:59], v[68:83]
    v_mfma_f32_32x32x16_bf16 v[68:83], v[88:91], v[60:63], v[68:83]
    v_mfma_f32_32x32x16_bf16 v[68:83], v[92:95], v[64:67], v[68:83]
L_csb1:
    s_waitcnt lgkmcnt(0)
    v_mfma_f32_32x32x16_bf16 v[160:175], v[44:47], a[8:11], v[160:175]
    ds_read_b64_tr_b16 v[56:57], v25 offset:15360
    ds_read_b64_tr_b16 v[58:59], v25 offset:15616
    v_lshlrev_b32 v7, 16, v36
    v_sub_f32_e64 v7, -v100, v7
    v_cvt_pk_bf16_f32 v37, v7, 0
    v_cndmask_b32 v36, 0, v36, s[76:77]
    v_cndmask_b32 v37, 0, v37, s[76:77]
    v_mfma_f32_32x32x16_bf16 v[176:191], v[48:51], a[8:11], v[176:191]
    ds_read_b64_tr_b16 v[60:61], v26 offset:15360
    ds_read_b64_tr_b16 v[62:63], v26 offset:15872
    v_mov_b32 v38, 0
    v_mov_b32 v39, 0
    v_cvt_pk_bf16_f32 v121, v104, 0
    v_lshlrev_b32 v105, 16, v121
    v_sub_f32 v105, v104, v105
    v_mfma_f32_32x32x16_bf16 v[192:207], v[48:51], a[136:139], v[192:207]
    ds_read_b64_tr_b16 v[64:65], v27 offset:15360
    ds_read_b64_tr_b16 v[66:67], v27 offset:15872
    v_cvt_pk_bf16_f32 v120, v104, v105
    v_mov_b32 v122, 0
    v_mov_b32 v123, 0
    s_nop 1
    v_mfma_f32_32x32x16_bf16 v[128:143], v[120:123], v[32:35], v[128:143]
    v_mfma_f32_32x32x16_bf16 v[208:223], v[52:55], a[8:11], v[208:223]
    v_mfma_f32_32x32x16_bf16 v[144:159], v[120:123], v[36:39], v[144:159]
    v_mov_b32 v30, v97
    v_mov_b32 v31, v101
    v_mfma_f32_32x32x16_bf16 v[224:239], v[52:55], a[136:139], v[224:239]
    s_and_b32 s78, s5, 14
    s_add_u32 s78, s78, s41
    s_lshl_b32 s78, s78, 17
    s_and_b32 s79, s5, 1
    s_mul_i32 s63, s79, 2097152
    s_add_u32 s78, s78, s63
    s_add_u32 s78, s78, 1048576
    s_bitcmp1_b32 s4, 0
    s_cbranch_scc0 L_csb2
    v_mfma_f32_32x32x16_bf16 v[68:83], v[84:87], v[44:47], 0
    v_mfma_f32_32x32x16_bf16 v[68:83], v[88:91], v[48:51], v[68:83]
    v_mfma_f32_32x32x16_bf16 v[68:83], v[92:95], v[52:55], v[68:83]
L_csb2:
    s_waitcnt lgkmcnt(0)
    v_mfma_f32_32x32x16_bf16 v[160:175], v[56:59], a[12:15], v[160:175]
    s_waitcnt vmcnt(5)
    s_barrier
    ds_read_b64_tr_b16 v[44:45], v25 offset:20480
    ds_read_b64_tr_b16 v[46:47], v25 offset:20736
    s_lshl_b32 s80, s51, 10
    s_add_u32 s80, s80, s78
    s_lshl_b32 s81, s52, 10
    v_mfma_f32_32x32x16_bf16 v[176:191], v[60:63], a[12:15], v[176:191]
    s_add_u32 m0, s62, 0
    ds_read_b64_tr_b16 v[48:49], v26 offset:20480
    ds_read_b64_tr_b16 v[50:51], v26 offset:20992
    buffer_load_dwordx4 v14, s[12:15], s60 offen lds
    s_add_u32 s60, s60, 196608
    s_cmp_ge_u32 s60, s61
    s_cselect_b32 s3, 1572864, 0
    s_sub_u32 s60, s60, s3
    v_mfma_f32_32x32x16_bf16 v[192:207], v[60:63], a[140:143], v[192:207]
    ds_read_b64_tr_b16 v[52:53], v27 offset:20480
    ds_read_b64_tr_b16 v[54:55], v27 offset:20992
    s_add_u32 s81, s81, s78
    s_sub_u32 s63, s79, 1
    v_mov_b32 v12, 0x0da24260
    v_mul_f32 v128, v128, v30
    v_mul_f32 v129, v129, v30
    v_mfma_f32_32x32x16_bf16 v[208:223], v[64:67], a[12:15], v[208:223]
    s_addk_i32 m0, 1024
    s_nop 0
    buffer_load_dwordx4 v15, s[20:23], s46 offen lds
    v_mul_f32 v130, v130, v30
    v_mul_f32 v131, v131, v30
    v_mul_f32 v132, v132, v30
    v_mul_f32 v133, v133, v30
    v_mfma_f32_32x32x16_bf16 v[224:239], v[64:67], a[140:143], v[224:239]
    v_mul_f32 v134, v134, v30
    v_mul_f32 v135, v135, v30
    v_mul_f32 v136, v136, v30
    v_mul_f32 v137, v137, v30
    v_mul_f32 v138, v138, v30
    v_mul_f32 v139, v139, v30
    v_mul_f32 v140, v140, v30
    s_bitcmp1_b32 s4, 0
    s_cbranch_scc0 L_csb3
    v_mfma_f32_32x32x16_bf16 v[68:83], v[84:87], v[56:59], v[68:83]
    v_mfma_f32_32x32x16_bf16 v[68:83], v[88:91], v[60:63], v[68:83]
    v_mfma_f32_32x32x16_bf16 v[68:83], v[92:95], v[64:67], v[68:83]
L_csb3:
    s_waitcnt lgkmcnt(0)
    v_mfma_f32_32x32x16_bf16 v[160:175], v[44:47], a[16:19], v[160:175]
    ds_read_b64_tr_b16 v[56:57], v25 offset:25600
    ds_read_b64_tr_b16 v[58:59], v25 offset:25856
    s_lshl_b32 s101, s5, 1
    s_add_u32 s101, s101, s41
    s_lshl_b32 s101, s101, 4
    s_add_u32 s101, s101, s4
    s_lshl_b32 s101, s101, 9
    v_mfma_f32_32x32x16_bf16 v[176:191], v[48:51], a[16:19], v[176:191]
    s_addk_i32 m0, 1024
    ds_read_b64_tr_b16 v[60:61], v26 offset:25600
    ds_read_b64_tr_b16 v[62:63], v26 offset:26112
    buffer_load_dwordx4 v29, s[20:23], s46 offen lds
    s_add_u32 s101, s101, 262144
    s_cmp_eq_u32 s40, 0
    s_cselect_b32 s101, s101, s100
    v_mfma_f32_32x32x16_bf16 v[192:207], v[48:51], a[144:147], v[192:207]
    ds_read_b64_tr_b16 v[64:65], v27 offset:25600
    ds_read_b64_tr_b16 v[66:67], v27 offset:26112
    v_and_b32 v11, 31, v1
    v_lshlrev_b32 v11, 4, v11
    v_mov_b32 v69, v72
    v_mov_b32 v70, v76
    v_mov_b32 v71, s47
    v_mfma_f32_32x32x16_bf16 v[208:223], v[52:55], a[16:19], v[208:223]
    s_addk_i32 m0, 896
    s_nop 0
    buffer_load_dwordx4 v15, s[20:23], s46 offen offset:128 lds
    buffer_store_dwordx4 v[68:71], v11, s[32:35], s101 offen sc1
    v_mul_f32 v141, v141, v30
    v_mul_f32 v142, v142, v30
    v_mfma_f32_32x32x16_bf16 v[224:239], v[52:55], a[144:147], v[224:239]
    v_mul_f32 v143, v143, v30
    v_cvt_pk_bf16_f32 v128, v128, v129
    v_cvt_pk_bf16_f32 v129, v130, v131
    v_cvt_pk_bf16_f32 v130, v132, v133
    v_cvt_pk_bf16_f32 v131, v134, v135
    v_cvt_pk_bf16_f32 v132, v136, v137
    v_cvt_pk_bf16_f32 v133, v138, v139
    s_waitcnt lgkmcnt(0)
    v_mfma_f32_32x32x16_bf16 v[160:175], v[56:59], a[20:23], v[160:175]
    ds_read_b64_tr_b16 v[44:45], v25 offset:30720
    ds_read_b64_tr_b16 v[46:47], v25 offset:30976
    v_cvt_pk_bf16_f32 v134, v140, v141
    v_cvt_pk_bf16_f32 v135, v142, v143
    buffer_store_dwordx4 v[128:131], v255, s[32:35], s80 offen sc1
    s_add_u32 s80, s80, 65536
    v_mfma_f32_32x32x16_bf16 v[176:191], v[60:63], a[20:23], v[176:191]
    s_addk_i32 m0, 1024
    ds_read_b64_tr_b16 v[48:49], v26 offset:30720
    ds_read_b64_tr_b16 v[50:51], v26 offset:31232
    buffer_load_dwordx4 v29, s[20:23], s46 offen offset:128 lds
    s_add_u32 s46, s46, 229376
    s_cmp_ge_u32 s46, s50
    s_cselect_b32 s3, 1835008, 0
    s_sub_u32 s46, s46, s3
    v_mfma_f32_32x32x16_bf16 v[192:207], v[60:63], a[148:151], v[192:207]
    ds_read_b64_tr_b16 v[52:53], v27 offset:30720
    ds_read_b64_tr_b16 v[54:55], v27 offset:31232
    buffer_store_dwordx4 v[132:135], v255, s[32:35], s80 offen sc1
    v_mul_f32 v144, v144, v31
    v_mul_f32 v145, v145, v31
    v_mul_f32 v146, v146, v31
    v_mfma_f32_32x32x16_bf16 v[208:223], v[64:67], a[20:23], v[208:223]
    v_mul_f32 v147, v147, v31
    v_mul_f32 v148, v148, v31
    v_mul_f32 v149, v149, v31
    v_mul_f32 v150, v150, v31
    v_mul_f32 v151, v151, v31
    v_mul_f32 v152, v152, v31
    v_mul_f32 v153, v153, v31
    v_mfma_f32_32x32x16_bf16 v[224:239], v[64:67], a[148:151], v[224:239]
    v_mul_f32 v154, v154, v31
    v_mul_f32 v155, v155, v31
    v_mul_f32 v156, v156, v31
    v_mul_f32 v157, v157, v31
    v_mul_f32 v158, v158, v31
    v_mul_f32 v159, v159, v31
    v_cvt_pk_bf16_f32 v144, v144, v145
    s_waitcnt lgkmcnt(0)
    v_mfma_f32_32x32x16_bf16 v[160:175], v[44:47], a[24:27], v[160:175]
    ds_read_b64_tr_b16 v[56:57], v25 offset:35840
    ds_read_b64_tr_b16 v[58:59], v25 offset:36096
    v_cvt_pk_bf16_f32 v145, v146, v147
    v_cvt_pk_bf16_f32 v146, v148, v149
    v_cvt_pk_bf16_f32 v147, v150, v151
    v_cvt_pk_bf16_f32 v148, v152, v153
    v_cvt_pk_bf16_f32 v149, v154, v155
    v_mfma_f32_32x32x16_bf16 v[176:191], v[48:51], a[24:27], v[176:191]
    ds_read_b64_tr_b16 v[60:61], v26 offset:35840
    ds_read_b64_tr_b16 v[62:63], v26 offset:36352
    v_cvt_pk_bf16_f32 v150, v156, v157
    v_cvt_pk_bf16_f32 v151, v158, v159
    buffer_store_dwordx4 v[144:147], v255, s[32:35], s81 offen sc1
    s_add_u32 s81, s81, 65536
    v_mfma_f32_32x32x16_bf16 v[192:207], v[48:51], a[152:155], v[192:207]
    ds_read_b64_tr_b16 v[64:65], v27 offset:35840
    ds_read_b64_tr_b16 v[66:67], v27 offset:36352
    buffer_store_dwordx4 v[148:151], v255, s[32:35], s81 offen sc1
    v_dot2_f32_bf16 v2, v128, v128, 0
    v_dot2_f32_bf16 v3, v132, v132, 0
    v_dot2_f32_bf16 v2, v129, v129, v2
    v_dot2_f32_bf16 v3, v133, v133, v3
    v_dot2_f32_bf16 v2, v130, v130, v2
    v_dot2_f32_bf16 v3, v134, v134, v3
    v_dot2_f32_bf16 v2, v131, v131, v2
    v_dot2_f32_bf16 v3, v135, v135, v3
    s_nop 2
    v_max3_f32 v12, v12, v2, v3
    v_mfma_f32_32x32x16_bf16 v[208:223], v[52:55], a[24:27], v[208:223]
    v_dot2_f32_bf16 v2, v144, v144, 0
    v_dot2_f32_bf16 v3, v148, v148, 0
    v_dot2_f32_bf16 v2, v145, v145, v2
    v_dot2_f32_bf16 v3, v149, v149, v3
    v_dot2_f32_bf16 v2, v146, v146, v2
    v_dot2_f32_bf16 v3, v150, v150, v3
    v_dot2_f32_bf16 v2, v147, v147, v2
    v_dot2_f32_bf16 v3, v151, v151, v3
    s_nop 2
    v_max3_f32 v12, v12, v2, v3
    v_mfma_f32_32x32x16_bf16 v[224:239], v[52:55], a[152:155], v[224:239]
    s_nop 0
    v_max_f32_dpp v12, v12, v12 quad_perm:[1,0,3,2] row_mask:0xf bank_mask:0xf
    s_nop 1
    v_max_f32_dpp v12, v12, v12 quad_perm:[2,3,0,1] row_mask:0xf bank_mask:0xf
    s_nop 1
    v_max_f32_dpp v12, v12, v12 row_half_mirror row_mask:0xf bank_mask:0xf
    s_nop 1
    v_max_f32_dpp v12, v12, v12 row_mirror row_mask:0xf bank_mask:0xf
    v_mov_b32 v7, v12
    s_nop 1
    v_permlane16_swap_b32 v7, v12
    v_max_f32 v12, v12, v7
    s_waitcnt lgkmcnt(0)
    v_mfma_f32_32x32x16_bf16 v[160:175], v[56:59], a[28:31], v[160:175]
    s_waitcnt vmcnt(10)
    s_barrier
    ds_read_b64_tr_b16 v[44:45], v25 offset:40960
    ds_read_b64_tr_b16 v[46:47], v25 offset:41216
    v_mov_b32 v7, v12
    s_nop 1
    v_permlane32_swap_b32 v7, v12
    v_max_f32 v12, v12, v7
    v_mfma_f32_32x32x16_bf16 v[176:191], v[60:63], a[28:31], v[176:191]
    s_add_u32 m0, s62, 20480
    ds_read_b64_tr_b16 v[48:49], v26 offset:40960
    ds_read_b64_tr_b16 v[50:51], v26 offset:41472
    buffer_load_dwordx4 v14, s[12:15], s60 offen lds
    s_add_u32 s60, s60, 196608
    s_cmp_ge_u32 s60, s61
    s_cselect_b32 s3, 1572864, 0
    s_sub_u32 s60, s60, s3
    v_mfma_f32_32x32x16_bf16 v[192:207], v[60:63], a[156:159], v[192:207]
    ds_read_b64_tr_b16 v[52:53], v27 offset:40960
    ds_read_b64_tr_b16 v[54:55], v27 offset:41472
    v_and_b32 v12, s63, v12
    v_mfma_f32_32x32x16_bf16 v[208:223], v[64:67], a[28:31], v[208:223]
    s_addk_i32 m0, 1024
    s_nop 0
    buffer_load_dwordx4 v15, s[20:23], s46 offen lds
    v_mfma_f32_32x32x16_bf16 v[224:239], v[64:67], a[156:159], v[224:239]
    s_waitcnt lgkmcnt(0)
    v_mfma_f32_32x32x16_bf16 v[160:175], v[44:47], a[32:35], v[160:175]
    ds_read_b64_tr_b16 v[56:57], v25 offset:46080
    ds_read_b64_tr_b16 v[58:59], v25 offset:46336
    v_mfma_f32_32x32x16_bf16 v[176:191], v[48:51], a[32:35], v[176:191]
    s_addk_i32 m0, 1024
    ds_read_b64_tr_b16 v[60:61], v26 offset:46080
    ds_read_b64_tr_b16 v[62:63], v26 offset:46592
    buffer_load_dwordx4 v29, s[20:23], s46 offen lds
    v_mfma_f32_32x32x16_bf16 v[192:207], v[48:51], a[160:163], v[192:207]
    ds_read_b64_tr_b16 v[64:65], v27 offset:46080
    ds_read_b64_tr_b16 v[66:67], v27 offset:46592
    v_mfma_f32_32x32x16_bf16 v[208:223], v[52:55], a[32:35], v[208:223]
    s_addk_i32 m0, 896
    s_nop 0
    buffer_load_dwordx4 v15, s[20:23], s46 offen offset:128 lds
    v_mfma_f32_32x32x16_bf16 v[224:239], v[52:55], a[160:163], v[224:239]
    s_waitcnt lgkmcnt(0)
    v_mfma_f32_32x32x16_bf16 v[160:175], v[56:59], a[36:39], v[160:175]
    ds_read_b64_tr_b16 v[44:45], v25 offset:51200
    ds_read_b64_tr_b16 v[46:47], v25 offset:51456
    v_mfma_f32_32x32x16_bf16 v[176:191], v[60:63], a[36:39], v[176:191]
    s_addk_i32 m0, 1024
    ds_read_b64_tr_b16 v[48:49], v26 offset:51200
    ds_read_b64_tr_b16 v[50:51], v26 offset:51712
    buffer_load_dwordx4 v29, s[20:23], s46 offen offset:128 lds
    s_add_u32 s46, s46, 229376
    s_cmp_ge_u32 s46, s50
    s_cselect_b32 s3, 1835008, 0
    s_sub_u32 s46, s46, s3
    v_mfma_f32_32x32x16_bf16 v[192:207], v[60:63], a[164:167], v[192:207]
    ds_read_b64_tr_b16 v[52:53], v27 offset:51200
    ds_read_b64_tr_b16 v[54:55], v27 offset:51712
    v_mfma_f32_32x32x16_bf16 v[208:223], v[64:67], a[36:39], v[208:223]
    v_mfma_f32_32x32x16_bf16 v[224:239], v[64:67], a[164:167], v[224:239]
    s_waitcnt lgkmcnt(0)
    v_mfma_f32_32x32x16_bf16 v[160:175], v[44:47], a[40:43], v[160:175]
    ds_read_b64_tr_b16 v[56:57], v25 offset:56320
    ds_read_b64_tr_b16 v[58:59], v25 offset:56576
    v_mfma_f32_32x32x16_bf16 v[176:191], v[48:51], a[40:43], v[176:191]
    ds_read_b64_tr_b16 v[60:61], v26 offset:56320
    ds_read_b64_tr_b16 v[62:63], v26 offset:56832
    v_mfma_f32_32x32x16_bf16 v[192:207], v[48:51], a[168:171], v[192:207]
    ds_read_b64_tr_b16 v[64:65], v27 offset:56320
    ds_read_b64_tr_b16 v[66:67], v27 offset:56832
    v_mfma_f32_32x32x16_bf16 v[208:223], v[52:55], a[40:43], v[208:223]
    v_mfma_f32_32x32x16_bf16 v[224:239], v[52:55], a[168:171], v[224:239]
    s_waitcnt lgkmcnt(0)
    v_mfma_f32_32x32x16_bf16 v[160:175], v[56:59], a[44:47], v[160:175]
    s_waitcnt vmcnt(8)
    s_barrier
    ds_read_b64_tr_b16 v[44:45], v25 offset:0
    ds_read_b64_tr_b16 v[46:47], v25 offset:256
    v_mfma_f32_32x32x16_bf16 v[176:191], v[60:63], a[44:47], v[176:191]
    s_add_u32 m0, s62, 40960
    ds_read_b64_tr_b16 v[48:49], v26 offset:0
    ds_read_b64_tr_b16 v[50:51], v26 offset:512
    buffer_load_dwordx4 v14, s[12:15], s60 offen lds
    s_add_u32 s60, s60, 196608
    s_cmp_ge_u32 s60, s61
    s_cselect_b32 s3, 1572864, 0
    s_sub_u32 s60, s60, s3
    v_mfma_f32_32x32x16_bf16 v[192:207], v[60:63], a[172:175], v[192:207]
    ds_read_b64_tr_b16 v[52:53], v27 offset:0
    ds_read_b64_tr_b16 v[54:55], v27 offset:512
    v_mfma_f32_32x32x16_bf16 v[208:223], v[64:67], a[44:47], v[208:223]
    s_addk_i32 m0, 1024
    s_nop 0
    buffer_load_dwordx4 v15, s[20:23], s46 offen lds
    v_mfma_f32_32x32x16_bf16 v[224:239], v[64:67], a[172:175], v[224:239]
    s_waitcnt lgkmcnt(0)
    v_mfma_f32_32x32x16_bf16 v[160:175], v[44:47], a[48:51], v[160:175]
    ds_read_b64_tr_b16 v[56:57], v25 offset:5120
    ds_read_b64_tr_b16 v[58:59], v25 offset:5376
    v_mfma_f32_32x32x16_bf16 v[176:191], v[48:51], a[48:51], v[176:191]
    s_addk_i32 m0, 1024
    ds_read_b64_tr_b16 v[60:61], v26 offset:5120
    ds_read_b64_tr_b16 v[62:63], v26 offset:5632
    buffer_load_dwordx4 v29, s[20:23], s46 offen lds
    v_mfma_f32_32x32x16_bf16 v[192:207], v[48:51], a[176:179], v[192:207]
    ds_read_b64_tr_b16 v[64:65], v27 offset:5120
    ds_read_b64_tr_b16 v[66:67], v27 offset:5632
    v_mfma_f32_32x32x16_bf16 v[208:223], v[52:55], a[48:51], v[208:223]
    s_addk_i32 m0, 896
    s_nop 0
    buffer_load_dwordx4 v15, s[20:23], s46 offen offset:128 lds
    v_mfma_f32_32x32x16_bf16 v[224:239], v[52:55], a[176:179], v[224:239]
    s_waitcnt lgkmcnt(0)
    v_mfma_f32_32x32x16_bf16 v[160:175], v[56:59], a[52:55], v[160:175]
    ds_read_b64_tr_b16 v[44:45], v25 offset:10240
    ds_read_b64_tr_b16 v[46:47], v25 offset:10496
    s_lshl_b32 s101, s4, 4
    s_add_u32 s101, s101, s5
    s_lshl_b32 s101, s101, 2
    v_mfma_f32_32x32x16_bf16 v[176:191], v[60:63], a[52:55], v[176:191]
    s_addk_i32 m0, 1024
    ds_read_b64_tr_b16 v[48:49], v26 offset:10240
    ds_read_b64_tr_b16 v[50:51], v26 offset:10752
    buffer_load_dwordx4 v29, s[20:23], s46 offen offset:128 lds
    s_add_u32 s46, s46, 229376
    s_cmp_ge_u32 s46, s50
    s_cselect_b32 s3, 1835008, 0
    s_sub_u32 s46, s46, s3
    v_mfma_f32_32x32x16_bf16 v[192:207], v[60:63], a[180:183], v[192:207]
    ds_read_b64_tr_b16 v[52:53], v27 offset:10240
    ds_read_b64_tr_b16 v[54:55], v27 offset:10752
    s_add_u32 s101, s101, s6
    s_lshl_b32 s101, s101, 2
    s_mul_i32 s56, s51, 114688
    v_mfma_f32_32x32x16_bf16 v[208:223], v[64:67], a[52:55], v[208:223]
    s_mul_i32 s57, s52, 114688
    s_lshl_b32 s78, s41, 1
    s_add_u32 s78, s78, s42
    s_lshl_b32 s78, s78, 11
    s_add_u32 s78, s78, 9437184
    v_mfma_f32_32x32x16_bf16 v[224:239], v[64:67], a[180:183], v[224:239]
    s_add_u32 s56, s56, s78
    s_add_u32 s57, s57, s78
    s_cmp_ge_u32 s5, 14
    s_cselect_b32 s56, s100, s56
    s_cselect_b32 s57, s100, s57
    s_waitcnt lgkmcnt(0)
    v_mfma_f32_32x32x16_bf16 v[160:175], v[44:47], a[56:59], v[160:175]
    ds_read_b64_tr_b16 v[56:57], v25 offset:15360
    ds_read_b64_tr_b16 v[58:59], v25 offset:15616
    v_mfma_f32_32x32x16_bf16 v[176:191], v[48:51], a[56:59], v[176:191]
    ds_read_b64_tr_b16 v[60:61], v26 offset:15360
    ds_read_b64_tr_b16 v[62:63], v26 offset:15872
    v_mfma_f32_32x32x16_bf16 v[192:207], v[48:51], a[184:187], v[192:207]
    ds_read_b64_tr_b16 v[64:65], v27 offset:15360
    ds_read_b64_tr_b16 v[66:67], v27 offset:15872
    v_mfma_f32_32x32x16_bf16 v[208:223], v[52:55], a[56:59], v[208:223]
    v_mfma_f32_32x32x16_bf16 v[224:239], v[52:55], a[184:187], v[224:239]
    s_waitcnt lgkmcnt(0)
    v_mfma_f32_32x32x16_bf16 v[160:175], v[56:59], a[60:63], v[160:175]
    s_waitcnt vmcnt(5)
    s_barrier
    ds_read_b64_tr_b16 v[44:45], v25 offset:20480
    ds_read_b64_tr_b16 v[46:47], v25 offset:20736
    v_mfma_f32_32x32x16_bf16 v[176:191], v[60:63], a[60:63], v[176:191]
    s_add_u32 m0, s62, 0
    ds_read_b64_tr_b16 v[48:49], v26 offset:20480
    ds_read_b64_tr_b16 v[50:51], v26 offset:20992
    buffer_load_dwordx4 v14, s[12:15], s60 offen lds
    s_add_u32 s60, s60, 196608
    s_cmp_ge_u32 s60, s61
    s_cselect_b32 s3, 1572864, 0
    s_sub_u32 s60, s60, s3
    v_mfma_f32_32x32x16_bf16 v[192:207], v[60:63], a[188:191], v[192:207]
    ds_read_b64_tr_b16 v[52:53], v27 offset:20480
    ds_read_b64_tr_b16 v[54:55], v27 offset:20992
    v_mfma_f32_32x32x16_bf16 v[208:223], v[64:67], a[60:63], v[208:223]
    s_addk_i32 m0, 1024
    s_nop 0
    buffer_load_dwordx4 v15, s[20:23], s46 offen lds
    v_mfma_f32_32x32x16_bf16 v[224:239], v[64:67], a[188:191], v[224:239]
    s_waitcnt lgkmcnt(0)
    v_mfma_f32_32x32x16_bf16 v[160:175], v[44:47], a[64:67], v[160:175]
    ds_read_b64_tr_b16 v[56:57], v25 offset:25600
    ds_read_b64_tr_b16 v[58:59], v25 offset:25856
    v_mfma_f32_32x32x16_bf16 v[176:191], v[48:51], a[64:67], v[176:191]
    s_addk_i32 m0, 1024
    ds_read_b64_tr_b16 v[60:61], v26 offset:25600
    ds_read_b64_tr_b16 v[62:63], v26 offset:26112
    buffer_load_dwordx4 v29, s[20:23], s46 offen lds
    v_mfma_f32_32x32x16_bf16 v[192:207], v[48:51], a[192:195], v[192:207]
    ds_read_b64_tr_b16 v[64:65], v27 offset:25600
    ds_read_b64_tr_b16 v[66:67], v27 offset:26112
    v_mfma_f32_32x32x16_bf16 v[208:223], v[52:55], a[64:67], v[208:223]
    s_addk_i32 m0, 896
    s_nop 0
    buffer_load_dwordx4 v15, s[20:23], s46 offen offset:128 lds
    v_mfma_f32_32x32x16_bf16 v[224:239], v[52:55], a[192:195], v[224:239]
    s_waitcnt lgkmcnt(0)
    v_mfma_f32_32x32x16_bf16 v[160:175], v[56:59], a[68:71], v[160:175]
    ds_read_b64_tr_b16 v[44:45], v25 offset:30720
    ds_read_b64_tr_b16 v[46:47], v25 offset:30976
    s_waitcnt vmcnt(14)
    s_lshl_b32 s36, s101, 1
    s_add_u32 s36, s36, 17827840
    v_mov_b32 v4, s47
    v_mov_b32 v5, v12
    v_mov_b32 v2, 0
    s_mov_b64 exec, 1
    buffer_store_dwordx2 v[4:5], v2, s[32:35], s36 offen sc1
    s_mov_b64 exec, -1
    v_mfma_f32_32x32x16_bf16 v[176:191], v[60:63], a[68:71], v[176:191]
    s_addk_i32 m0, 1024
    ds_read_b64_tr_b16 v[48:49], v26 offset:30720
    ds_read_b64_tr_b16 v[50:51], v26 offset:31232
    buffer_load_dwordx4 v29, s[20:23], s46 offen offset:128 lds
    s_add_u32 s46, s46, 229376
    s_cmp_ge_u32 s46, s50
    s_cselect_b32 s3, 1835008, 0
    s_sub_u32 s46, s46, s3
    v_mfma_f32_32x32x16_bf16 v[192:207], v[60:63], a[196:199], v[192:207]
    ds_read_b64_tr_b16 v[52:53], v27 offset:30720
    ds_read_b64_tr_b16 v[54:55], v27 offset:31232
    v_mfma_f32_32x32x16_bf16 v[208:223], v[64:67], a[68:71], v[208:223]
    v_mfma_f32_32x32x16_bf16 v[224:239], v[64:67], a[196:199], v[224:239]
    s_waitcnt lgkmcnt(0)
    v_mfma_f32_32x32x16_bf16 v[160:175], v[44:47], a[72:75], v[160:175]
    ds_read_b64_tr_b16 v[56:57], v25 offset:35840
    ds_read_b64_tr_b16 v[58:59], v25 offset:36096
    s_lshl_b32 s80, s5, 1
    s_add_u32 s80, s80, s41
    s_lshl_b32 s80, s80, 13
    v_mfma_f32_32x32x16_bf16 v[176:191], v[48:51], a[72:75], v[176:191]
    ds_read_b64_tr_b16 v[60:61], v26 offset:35840
    ds_read_b64_tr_b16 v[62:63], v26 offset:36352
    s_add_u32 s80, s80, 262144
    s_add_u32 s81, s80, 4096
    buffer_load_dwordx4 v[96:99], v253, s[32:35], s80 offen offset:0 sc1
    v_mfma_f32_32x32x16_bf16 v[192:207], v[48:51], a[200:203], v[192:207]
    ds_read_b64_tr_b16 v[64:65], v27 offset:35840
    ds_read_b64_tr_b16 v[66:67], v27 offset:36352
    buffer_load_dwordx4 v[100:103], v253, s[32:35], s80 offen offset:1024 sc1
    buffer_load_dwordx4 v[104:107], v253, s[32:35], s80 offen offset:2048 sc1
    v_mfma_f32_32x32x16_bf16 v[208:223], v[52:55], a[72:75], v[208:223]
    buffer_load_dwordx4 v[108:111], v253, s[32:35], s80 offen offset:3072 sc1
    buffer_load_dwordx4 v[112:115], v253, s[32:35], s81 offen offset:0 sc1
    buffer_load_dwordx4 v[116:119], v253, s[32:35], s81 offen offset:1024 sc1
    v_mfma_f32_32x32x16_bf16 v[224:239], v[52:55], a[200:203], v[224:239]
    buffer_load_dwordx4 v[120:123], v253, s[32:35], s81 offen offset:2048 sc1
    buffer_load_dwordx4 v[124:127], v253, s[32:35], s81 offen offset:3072 sc1
    s_waitcnt lgkmcnt(0)
    v_mfma_f32_32x32x16_bf16 v[160:175], v[56:59], a[76:79], v[160:175]
    s_waitcnt vmcnt(14)
    s_barrier
    ds_read_b64_tr_b16 v[44:45], v25 offset:40960
    ds_read_b64_tr_b16 v[46:47], v25 offset:41216
    v_mfma_f32_32x32x16_bf16 v[176:191], v[60:63], a[76:79], v[176:191]
    s_add_u32 m0, s62, 20480
    ds_read_b64_tr_b16 v[48:49], v26 offset:40960
    ds_read_b64_tr_b16 v[50:51], v26 offset:41472
    buffer_load_dwordx4 v14, s[12:15], s60 offen lds
    s_add_u32 s60, s60, 196608
    s_cmp_ge_u32 s60, s61
    s_cselect_b32 s3, 1572864, 0
    s_sub_u32 s60, s60, s3
    v_mfma_f32_32x32x16_bf16 v[192:207], v[60:63], a[204:207], v[192:207]
    ds_read_b64_tr_b16 v[52:53], v27 offset:40960
    ds_read_b64_tr_b16 v[54:55], v27 offset:41472
    v_mfma_f32_32x32x16_bf16 v[208:223], v[64:67], a[76:79], v[208:223]
    s_addk_i32 m0, 1024
    s_nop 0
    buffer_load_dwordx4 v15, s[20:23], s46 offen lds
    v_mfma_f32_32x32x16_bf16 v[224:239], v[64:67], a[204:207], v[224:239]
    s_waitcnt lgkmcnt(0)
    v_mfma_f32_32x32x16_bf16 v[160:175], v[44:47], a[80:83], v[160:175]
    ds_read_b64_tr_b16 v[56:57], v25 offset:46080
    ds_read_b64_tr_b16 v[58:59], v25 offset:46336
    v_mfma_f32_32x32x16_bf16 v[176:191], v[48:51], a[80:83], v[176:191]
    s_addk_i32 m0, 1024
    ds_read_b64_tr_b16 v[60:61], v26 offset:46080
    ds_read_b64_tr_b16 v[62:63], v26 offset:46592
    buffer_load_dwordx4 v29, s[20:23], s46 offen lds
    v_mfma_f32_32x32x16_bf16 v[192:207], v[48:51], a[208:211], v[192:207]
    ds_read_b64_tr_b16 v[64:65], v27 offset:46080
    ds_read_b64_tr_b16 v[66:67], v27 offset:46592
    v_mfma_f32_32x32x16_bf16 v[208:223], v[52:55], a[80:83], v[208:223]
    s_addk_i32 m0, 896
    s_nop 0
    buffer_load_dwordx4 v15, s[20:23], s46 offen offset:128 lds
    v_mfma_f32_32x32x16_bf16 v[224:239], v[52:55], a[208:211], v[224:239]
    s_waitcnt lgkmcnt(0)
    v_mfma_f32_32x32x16_bf16 v[160:175], v[56:59], a[84:87], v[160:175]
    ds_read_b64_tr_b16 v[44:45], v25 offset:51200
    ds_read_b64_tr_b16 v[46:47], v25 offset:51456
    v_mfma_f32_32x32x16_bf16 v[176:191], v[60:63], a[84:87], v[176:191]
    s_addk_i32 m0, 1024
    ds_read_b64_tr_b16 v[48:49], v26 offset:51200
    ds_read_b64_tr_b16 v[50:51], v26 offset:51712
    buffer_load_dwordx4 v29, s[20:23], s46 offen offset:128 lds
    s_add_u32 s46, s46, 229376
    s_cmp_ge_u32 s46, s50
    s_cselect_b32 s3, 1835008, 0
    s_sub_u32 s46, s46, s3
    v_mfma_f32_32x32x16_bf16 v[192:207], v[60:63], a[212:215], v[192:207]
    ds_read_b64_tr_b16 v[52:53], v27 offset:51200
    ds_read_b64_tr_b16 v[54:55], v27 offset:51712
    v_mfma_f32_32x32x16_bf16 v[208:223], v[64:67], a[84:87], v[208:223]
    v_mfma_f32_32x32x16_bf16 v[224:239], v[64:67], a[212:215], v[224:239]
    s_waitcnt lgkmcnt(0)
    v_mfma_f32_32x32x16_bf16 v[160:175], v[44:47], a[88:91], v[160:175]
    ds_read_b64_tr_b16 v[56:57], v25 offset:56320
    ds_read_b64_tr_b16 v[58:59], v25 offset:56576
    v_mfma_f32_32x32x16_bf16 v[176:191], v[48:51], a[88:91], v[176:191]
    ds_read_b64_tr_b16 v[60:61], v26 offset:56320
    ds_read_b64_tr_b16 v[62:63], v26 offset:56832
    v_mfma_f32_32x32x16_bf16 v[192:207], v[48:51], a[216:219], v[192:207]
    ds_read_b64_tr_b16 v[64:65], v27 offset:56320
    ds_read_b64_tr_b16 v[66:67], v27 offset:56832
    v_mfma_f32_32x32x16_bf16 v[208:223], v[52:55], a[88:91], v[208:223]
    v_mfma_f32_32x32x16_bf16 v[224:239], v[52:55], a[216:219], v[224:239]
    s_waitcnt lgkmcnt(0)
    v_mfma_f32_32x32x16_bf16 v[160:175], v[56:59], a[92:95], v[160:175]
    s_waitcnt vmcnt(13)
    s_barrier
    s_sub_u32 s68, s68, 16384
    s_lshl_b32 s45, s6, 12
    ds_read_b64_tr_b16 v[44:45], v25 offset:0
    ds_read_b64_tr_b16 v[46:47], v25 offset:256
    v_mfma_f32_32x32x16_bf16 v[176:191], v[60:63], a[92:95], v[176:191]
    s_add_u32 m0, s72, 49152
    s_add_u32 s68, s68, 16384
    ds_read_b64_tr_b16 v[48:49], v26 offset:0
    ds_read_b64_tr_b16 v[50:51], v26 offset:512
    buffer_load_dwordx4 v252, s[24:27], s68 offen lds
    v_mfma_f32_32x32x16_bf16 v[192:207], v[60:63], a[220:223], v[192:207]
    ds_read_b64_tr_b16 v[52:53], v27 offset:0
    ds_read_b64_tr_b16 v[54:55], v27 offset:512
    v_mfma_f32_32x32x16_bf16 v[208:223], v[64:67], a[92:95], v[208:223]
    s_add_u32 m0, s72, 51200
    s_add_u32 s68, s68, 16384
    buffer_load_dwordx4 v252, s[24:27], s68 offen lds
    v_mfma_f32_32x32x16_bf16 v[224:239], v[64:67], a[220:223], v[224:239]
    s_waitcnt lgkmcnt(0)
    v_mfma_f32_32x32x16_bf16 v[160:175], v[44:47], a[96:99], v[160:175]
    ds_read_b64_tr_b16 v[56:57], v25 offset:5120
    ds_read_b64_tr_b16 v[58:59], v25 offset:5376
    buffer_load_dwordx2 v[68:69], v28, s[32:35], 0 offen sc1
    s_waitcnt vmcnt(8)
    v_min3_u32 v2, v99, v103, v107
    v_max3_u32 v3, v99, v103, v107
    v_min3_u32 v2, v2, v111, v115
    v_max3_u32 v3, v3, v111, v115
    v_min3_u32 v2, v2, v119, v123
    v_max3_u32 v3, v3, v119, v123
    v_min_u32 v2, v2, v127
    v_max_u32 v3, v3, v127
    v_xor_b32 v2, s47, v2
    v_xor_b32 v3, s47, v3
    v_or_b32 v2, v2, v3
    v_cmp_eq_u32 vcc, 0, v2
    s_nop 0
    s_cmp_eq_u64 vcc, -1
    s_cbranch_scc0 L_gb_spin
L_gb_ok:
    v_mfma_f32_32x32x16_bf16 v[176:191], v[48:51], a[96:99], v[176:191]
    s_add_u32 m0, s72, 53248
    s_add_u32 s68, s68, 16384
    ds_read_b64_tr_b16 v[60:61], v26 offset:5120
    ds_read_b64_tr_b16 v[62:63], v26 offset:5632
    buffer_load_dwordx4 v252, s[24:27], s68 offen lds
    v_mfma_f32_32x32x16_bf16 v[192:207], v[48:51], a[224:227], v[192:207]
    ds_read_b64_tr_b16 v[64:65], v27 offset:5120
    ds_read_b64_tr_b16 v[66:67], v27 offset:5632
    v_add_f32 v96, v96, v100
    v_add_f32 v97, v97, v101
    v_add_f32 v98, v98, v102
    v_mfma_f32_32x32x16_bf16 v[208:223], v[52:55], a[96:99], v[208:223]
    s_add_u32 m0, s72, 55296
    s_add_u32 s68, s68, 16384
    buffer_load_dwordx4 v252, s[24:27], s68 offen lds
    v_add_f32 v96, v96, v104
    v_mfma_f32_32x32x16_bf16 v[224:239], v[52:55], a[224:227], v[224:239]
    v_add_f32 v97, v97, v105
    v_add_f32 v98, v98, v106
    v_add_f32 v96, v96, v108
    v_add_f32 v97, v97, v109
    v_add_f32 v98, v98, v110
    s_waitcnt lgkmcnt(0)
    v_mfma_f32_32x32x16_bf16 v[160:175], v[56:59], a[100:103], v[160:175]
    ds_read_b64_tr_b16 v[44:45], v25 offset:10240
    ds_read_b64_tr_b16 v[46:47], v25 offset:10496
    v_add_f32 v96, v96, v112
    v_add_f32 v97, v97, v113
    v_add_f32 v98, v98, v114
    v_mfma_f32_32x32x16_bf16 v[176:191], v[60:63], a[100:103], v[176:191]
    s_add_u32 m0, s72, 131072
    s_add_u32 s68, s68, 16384
    ds_read_b64_tr_b16 v[48:49], v26 offset:10240
    ds_read_b64_tr_b16 v[50:51], v26 offset:10752
    buffer_load_dwordx4 v252, s[24:27], s68 offen lds
    v_mfma_f32_32x32x16_bf16 v[192:207], v[60:63], a[228:231], v[192:207]
    ds_read_b64_tr_b16 v[52:53], v27 offset:10240
    ds_read_b64_tr_b16 v[54:55], v27 offset:10752
    v_add_f32 v96, v96, v116
    v_add_f32 v97, v97, v117
    v_add_f32 v98, v98, v118
    v_mfma_f32_32x32x16_bf16 v[208:223], v[64:67], a[100:103], v[208:223]
    s_add_u32 m0, s72, 133120
    s_add_u32 s68, s68, 16384
    buffer_load_dwordx4 v252, s[24:27], s68 offen lds
    v_add_f32 v96, v96, v120
    v_mfma_f32_32x32x16_bf16 v[224:239], v[64:67], a[228:231], v[224:239]
    v_add_f32 v97, v97, v121
    v_add_f32 v98, v98, v122
    v_add_f32 v96, v96, v124
    v_add_f32 v97, v97, v125
    v_add_f32 v98, v98, v126
    s_waitcnt lgkmcnt(0)
    v_mfma_f32_32x32x16_bf16 v[160:175], v[44:47], a[104:107], v[160:175]
    ds_read_b64_tr_b16 v[56:57], v25 offset:15360
    ds_read_b64_tr_b16 v[58:59], v25 offset:15616
    v_mov_b32 v100, v96
    s_nop 1
    v_permlane32_swap_b32 v100, v96
    v_add_f32 v96, v96, v100
    v_mfma_f32_32x32x16_bf16 v[176:191], v[48:51], a[104:107], v[176:191]
    s_add_u32 m0, s72, 135168
    s_add_u32 s68, s68, 16384
    ds_read_b64_tr_b16 v[60:61], v26 offset:15360
    ds_read_b64_tr_b16 v[62:63], v26 offset:15872
    buffer_load_dwordx4 v252, s[24:27], s68 offen lds
    v_mfma_f32_32x32x16_bf16 v[192:207], v[48:51], a[232:235], v[192:207]
    ds_read_b64_tr_b16 v[64:65], v27 offset:15360
    ds_read_b64_tr_b16 v[66:67], v27 offset:15872
    v_mov_b32 v101, v97
    s_nop 1
    v_permlane32_swap_b32 v101, v97
    v_add_f32 v97, v97, v101
    v_mfma_f32_32x32x16_bf16 v[208:223], v[52:55], a[104:107], v[208:223]
    s_add_u32 m0, s72, 137216
    s_add_u32 s68, s68, 16384
    buffer_load_dwordx4 v252, s[24:27], s68 offen lds
    v_mov_b32 v102, v98
    v_mfma_f32_32x32x16_bf16 v[224:239], v[52:55], a[232:235], v[224:239]
    s_nop 0
    v_permlane32_swap_b32 v102, v98
    v_add_f32 v98, v98, v102
    v_cvt_pk_bf16_f32 v41, v96, 0
    v_lshlrev_b32 v100, 16, v41
    v_sub_f32 v100, v96, v100
    s_waitcnt lgkmcnt(0)
    v_mfma_f32_32x32x16_bf16 v[160:175], v[56:59], a[108:111], v[160:175]
    s_waitcnt vmcnt(9)
    s_barrier
    ds_read_b64_tr_b16 v[44:45], v25 offset:20480
    ds_read_b64_tr_b16 v[46:47], v25 offset:20736
    v_cvt_pk_bf16_f32 v40, v96, v100
    v_mfma_f32_32x32x16_bf16 v[176:191], v[60:63], a[108:111], v[176:191]
    ds_read_b64_tr_b16 v[48:49], v26 offset:20480
    ds_read_b64_tr_b16 v[50:51], v26 offset:20992
    v_mov_b32 v42, 0
    v_mov_b32 v43, 0
    v_cvt_pk_bf16_f32 v17, v97, 0
    v_mfma_f32_32x32x16_bf16 v[192:207], v[60:63], a[236:239], v[192:207]
    ds_read_b64_tr_b16 v[52:53], v27 offset:20480
    ds_read_b64_tr_b16 v[54:55], v27 offset:20992
    v_lshlrev_b32 v101, 16, v17
    v_sub_f32 v101, v97, v101
    v_cvt_pk_bf16_f32 v16, v97, v101
    v_mfma_f32_32x32x16_bf16 v[208:223], v[64:67], a[108:111], v[208:223]
    v_mov_b32 v18, 0
    v_mov_b32 v19, 0
    v_cvt_pk_bf16_f32 v21, v98, 0
    v_lshlrev_b32 v102, 16, v21
    v_sub_f32 v102, v98, v102
    v_mfma_f32_32x32x16_bf16 v[224:239], v[64:67], a[236:239], v[224:239]
    v_cvt_pk_bf16_f32 v20, v98, v102
    v_mov_b32 v22, 0
    v_mov_b32 v23, 0
    s_waitcnt vmcnt(6)
    v_bfe_u32 v2, v1, 2, 2
    v_min_u32 v2, 2, v2
    v_mov_b32 v3, s47
    v_cmp_gt_u32 vcc, v2, s4
    s_nop 1
    v_cndmask_b32 v68, v68, v3, vcc
    v_cmp_eq_u32 vcc, s47, v68
    s_nop 0
    s_cmp_eq_u64 vcc, -1
    s_cbranch_scc0 L_kv_spin
L_kv_ok:
    s_waitcnt lgkmcnt(0)
    v_mfma_f32_32x32x16_bf16 v[160:175], v[44:47], a[112:115], v[160:175]
    s_add_u32 s80, s58, 0
    s_cmp_ge_u32 s4, 2
    s_cselect_b32 s81, s80, s100
    s_add_u32 m0, s59, 0
    ds_read_b64_tr_b16 v[56:57], v25 offset:25600
    ds_read_b64_tr_b16 v[58:59], v25 offset:25856
    buffer_load_dwordx4 v253, s[32:35], s81 offen offset:0 sc1 lds
    v_mfma_f32_32x32x16_bf16 v[176:191], v[48:51], a[112:115], v[176:191]
    ds_read_b64_tr_b16 v[60:61], v26 offset:25600
    ds_read_b64_tr_b16 v[62:63], v26 offset:26112
    v_mfma_f32_32x32x16_bf16 v[192:207], v[48:51], a[240:243], v[192:207]
    s_add_u32 m0, s59, 1024
    ds_read_b64_tr_b16 v[64:65], v27 offset:25600
    ds_read_b64_tr_b16 v[66:67], v27 offset:26112
    buffer_load_dwordx4 v253, s[32:35], s81 offen offset:1024 sc1 lds
    v_mfma_f32_32x32x16_bf16 v[208:223], v[52:55], a[112:115], v[208:223]
    v_mfma_f32_32x32x16_bf16 v[224:239], v[52:55], a[240:243], v[224:239]
    s_add_u32 m0, s59, 2048
    s_nop 0
    buffer_load_dwordx4 v253, s[32:35], s81 offen offset:2048 sc1 lds
    s_waitcnt lgkmcnt(0)
    v_mfma_f32_32x32x16_bf16 v[160:175], v[56:59], a[116:119], v[160:175]
    s_add_u32 m0, s59, 3072
    ds_read_b64_tr_b16 v[44:45], v25 offset:30720
    ds_read_b64_tr_b16 v[46:47], v25 offset:30976
    buffer_load_dwordx4 v253, s[32:35], s81 offen offset:3072 sc1 lds
    v_mfma_f32_32x32x16_bf16 v[176:191], v[60:63], a[116:119], v[176:191]
    ds_read_b64_tr_b16 v[48:49], v26 offset:30720
    ds_read_b64_tr_b16 v[50:51], v26 offset:31232
    v_mfma_f32_32x32x16_bf16 v[192:207], v[60:63], a[244:247], v[192:207]
    s_add_u32 s80, s58, 4096
    s_cmp_ge_u32 s4, 1
    s_cselect_b32 s81, s80, s100
    s_add_u32 m0, s59, 8192
    ds_read_b64_tr_b16 v[52:53], v27 offset:30720
    ds_read_b64_tr_b16 v[54:55], v27 offset:31232
    buffer_load_dwordx4 v253, s[32:35], s81 offen offset:0 sc1 lds
    v_mfma_f32_32x32x16_bf16 v[208:223], v[64:67], a[116:119], v[208:223]
    v_mfma_f32_32x32x16_bf16 v[224:239], v[64:67], a[244:247], v[224:239]
    s_add_u32 m0, s59, 9216
    s_nop 0
    buffer_load_dwordx4 v253, s[32:35], s81 offen offset:1024 sc1 lds
    s_waitcnt lgkmcnt(0)
    v_mfma_f32_32x32x16_bf16 v[160:175], v[44:47], a[120:123], v[160:175]
    s_add_u32 m0, s59, 10240
    ds_read_b64_tr_b16 v[56:57], v25 offset:35840
    ds_read_b64_tr_b16 v[58:59], v25 offset:36096
    buffer_load_dwordx4 v253, s[32:35], s81 offen offset:2048 sc1 lds
    v_mfma_f32_32x32x16_bf16 v[176:191], v[48:51], a[120:123], v[176:191]
    ds_read_b64_tr_b16 v[60:61], v26 offset:35840
    ds_read_b64_tr_b16 v[62:63], v26 offset:36352
    v_mfma_f32_32x32x16_bf16 v[192:207], v[48:51], a[248:251], v[192:207]
    s_add_u32 m0, s59, 11264
    ds_read_b64_tr_b16 v[64:65], v27 offset:35840
    ds_read_b64_tr_b16 v[66:67], v27 offset:36352
    buffer_load_dwordx4 v253, s[32:35], s81 offen offset:3072 sc1 lds
    v_mfma_f32_32x32x16_bf16 v[208:223], v[52:55], a[120:123], v[208:223]
    v_mfma_f32_32x32x16_bf16 v[224:239], v[52:55], a[248:251], v[224:239]
    s_add_u32 s80, s58, 8192
    s_cmp_ge_u32 s4, 0
    s_cselect_b32 s81, s80, s100
    s_add_u32 m0, s59, 16384
    s_nop 0
    buffer_load_dwordx4 v253, s[32:35], s81 offen offset:0 sc1 lds
    s_waitcnt lgkmcnt(0)
    v_mfma_f32_32x32x16_bf16 v[160:175], v[56:59], a[124:127], v[160:175]
    s_add_u32 m0, s59, 17408
    s_nop 0
    buffer_load_dwordx4 v253, s[32:35], s81 offen offset:1024 sc1 lds
    v_mfma_f32_32x32x16_bf16 v[176:191], v[60:63], a[124:127], v[176:191]
    v_mfma_f32_32x32x16_bf16 v[192:207], v[60:63], a[252:255], v[192:207]
    s_add_u32 m0, s59, 18432
    s_nop 0
    buffer_load_dwordx4 v253, s[32:35], s81 offen offset:2048 sc1 lds
    v_mfma_f32_32x32x16_bf16 v[208:223], v[64:67], a[124:127], v[208:223]
    v_mfma_f32_32x32x16_bf16 v[224:239], v[64:67], a[252:255], v[224:239]
    s_add_u32 m0, s59, 19456
    s_nop 0
    buffer_load_dwordx4 v253, s[32:35], s81 offen offset:3072 sc1 lds
    v_mfma_f32_32x32x16_bf16 v[176:191], v[16:19], v[32:35], v[176:191]
    v_mfma_f32_32x32x16_bf16 v[192:207], v[16:19], v[36:39], v[192:207]
    v_mfma_f32_32x32x16_bf16 v[208:223], v[20:23], v[32:35], v[208:223]
    v_mfma_f32_32x32x16_bf16 v[224:239], v[20:23], v[36:39], v[224:239]
    v_mfma_f32_32x32x16_bf16 v[160:175], v[40:43], v[32:35], v[160:175]
    v_mul_f32 v6, 0x3eb8aa3b, v30
    v_max_f32_dpp v69, v69, v69 quad_perm:[1,0,3,2] row_mask:0xf bank_mask:0xf
    s_nop 1
    v_max_f32_dpp v69, v69, v69 quad_perm:[2,3,0,1] row_mask:0xf bank_mask:0xf
    s_nop 1
    v_max_f32_dpp v69, v69, v69 row_half_mirror row_mask:0xf bank_mask:0xf
    s_nop 1
    v_max_f32_dpp v69, v69, v69 row_mirror row_mask:0xf bank_mask:0xf
    s_nop 2
    v_cvt_pk_bf16_f32 v176, v176, v177
    s_nop 1
    v_cvt_pk_bf16_f32 v177, v178, v179
    s_nop 0
    v_cvt_pk_bf16_f32 v178, v180, v181
    v_cvt_pk_bf16_f32 v179, v182, v183
    v_cvt_pk_bf16_f32 v180, v184, v185
    v_cvt_pk_bf16_f32 v181, v186, v187
    v_cvt_pk_bf16_f32 v182, v188, v189
    v_cvt_pk_bf16_f32 v183, v190, v191
    v_pk_max_i16 v176, v176, 0
    v_pk_max_i16 v177, v177, 0
    v_pk_max_i16 v178, v178, 0
    v_pk_max_i16 v179, v179, 0
    v_pk_max_i16 v180, v180, 0
    v_pk_max_i16 v181, v181, 0
    v_pk_max_i16 v182, v182, 0
    v_pk_max_i16 v183, v183, 0
    buffer_store_dwordx4 v[176:179], v253, s[32:35], s56 offen offset:0 sc1
    buffer_store_dwordx4 v[180:183], v253, s[32:35], s56 offen offset:1024 sc1
    v_cvt_pk_bf16_f32 v192, v192, v193
    v_cvt_pk_bf16_f32 v193, v194, v195
    v_cvt_pk_bf16_f32 v194, v196, v197
    v_cvt_pk_bf16_f32 v195, v198, v199
    v_cvt_pk_bf16_f32 v196, v200, v201
    v_cvt_pk_bf16_f32 v197, v202, v203
    v_cvt_pk_bf16_f32 v198, v204, v205
    v_cvt_pk_bf16_f32 v199, v206, v207
    v_pk_max_i16 v192, v192, 0
    v_pk_max_i16 v193, v193, 0
    v_pk_max_i16 v194, v194, 0
    v_pk_max_i16 v195, v195, 0
    v_pk_max_i16 v196, v196, 0
    v_pk_max_i16 v197, v197, 0
    v_pk_max_i16 v198, v198, 0
    v_pk_max_i16 v199, v199, 0
    buffer_store_dwordx4 v[192:195], v253, s[32:35], s57 offen offset:0 sc1
    buffer_store_dwordx4 v[196:199], v253, s[32:35], s57 offen offset:1024 sc1
    v_cvt_pk_bf16_f32 v208, v208, v209
    v_cvt_pk_bf16_f32 v209, v210, v211
    v_cvt_pk_bf16_f32 v210, v212, v213
    v_cvt_pk_bf16_f32 v211, v214, v215
    v_cvt_pk_bf16_f32 v212, v216, v217
    v_cvt_pk_bf16_f32 v213, v218, v219
    v_cvt_pk_bf16_f32 v214, v220, v221
    v_cvt_pk_bf16_f32 v215, v222, v223
    v_pk_max_i16 v208, v208, 0
    v_pk_max_i16 v209, v209, 0
    v_pk_max_i16 v210, v210, 0
    v_pk_max_i16 v211, v211, 0
    v_pk_max_i16 v212, v212, 0
    v_pk_max_i16 v213, v213, 0
    v_pk_max_i16 v214, v214, 0
    v_pk_max_i16 v215, v215, 0
    buffer_store_dwordx4 v[208:211], v253, s[32:35], s56 offen offset:2048 sc1
    buffer_store_dwordx4 v[212:215], v253, s[32:35], s56 offen offset:3072 sc1
    v_cvt_pk_bf16_f32 v224, v224, v225
    v_cvt_pk_bf16_f32 v225, v226, v227
    v_cvt_pk_bf16_f32 v226, v228, v229
    v_cvt_pk_bf16_f32 v227, v230, v231
    v_cvt_pk_bf16_f32 v228, v232, v233
    v_cvt_pk_bf16_f32 v229, v234, v235
    v_cvt_pk_bf16_f32 v230, v236, v237
    v_cvt_pk_bf16_f32 v231, v238, v239
    v_pk_max_i16 v224, v224, 0
    v_pk_max_i16 v225, v225, 0
    v_pk_max_i16 v226, v226, 0
    v_pk_max_i16 v227, v227, 0
    v_pk_max_i16 v228, v228, 0
    v_pk_max_i16 v229, v229, 0
    v_pk_max_i16 v230, v230, 0
    v_pk_max_i16 v231, v231, 0
    buffer_store_dwordx4 v[224:227], v253, s[32:35], s57 offen offset:2048 sc1
    buffer_store_dwordx4 v[228:231], v253, s[32:35], s57 offen offset:3072 sc1
    v_pk_mul_f32 v[160:161], v[160:161], v[6:7] op_sel:[0,0] op_sel_hi:[1,0]
    v_pk_mul_f32 v[162:163], v[162:163], v[6:7] op_sel:[0,0] op_sel_hi:[1,0]
    v_pk_mul_f32 v[164:165], v[164:165], v[6:7] op_sel:[0,0] op_sel_hi:[1,0]
    v_pk_mul_f32 v[166:167], v[166:167], v[6:7] op_sel:[0,0] op_sel_hi:[1,0]
    v_pk_mul_f32 v[168:169], v[168:169], v[6:7] op_sel:[0,0] op_sel_hi:[1,0]
    v_pk_mul_f32 v[170:171], v[170:171], v[6:7] op_sel:[0,0] op_sel_hi:[1,0]
    v_pk_mul_f32 v[172:173], v[172:173], v[6:7] op_sel:[0,0] op_sel_hi:[1,0]
    v_pk_mul_f32 v[174:175], v[174:175], v[6:7] op_sel:[0,0] op_sel_hi:[1,0]
    v_cvt_pk_bf16_f32 v8, v160, v161
    v_cvt_pk_bf16_f32 v9, v162, v163
    v_cvt_pk_bf16_f32 v10, v164, v165
    v_cvt_pk_bf16_f32 v11, v166, v167
    v_cvt_pk_bf16_f32 v12, v168, v169
    v_cvt_pk_bf16_f32 v13, v170, v171
    v_cvt_pk_bf16_f32 v14, v172, v173
    v_cvt_pk_bf16_f32 v15, v174, v175
    v_mov_b32 v223, v30
    v_mov_b32 v28, 0
    v_dot2_f32_bf16 v2, v8, v8, 0
    v_dot2_f32_bf16 v3, v12, v12, 0
    v_dot2_f32_bf16 v2, v9, v9, v2
    v_dot2_f32_bf16 v3, v13, v13, v3
    v_dot2_f32_bf16 v2, v10, v10, v2
    v_dot2_f32_bf16 v3, v14, v14, v3
    v_dot2_f32_bf16 v2, v11, v11, v2
    v_dot2_f32_bf16 v3, v15, v15, v3
    s_nop 2
    v_max3_f32 v28, v28, v2, v3
    s_nop 1
    v_max_f32_dpp v28, v28, v28 quad_perm:[1,0,3,2] row_mask:0xf bank_mask:0xf
    s_nop 1
    v_max_f32_dpp v28, v28, v28 quad_perm:[2,3,0,1] row_mask:0xf bank_mask:0xf
    s_nop 1
    v_max_f32_dpp v28, v28, v28 row_half_mirror row_mask:0xf bank_mask:0xf
    s_nop 1
    v_max_f32_dpp v28, v28, v28 row_mirror row_mask:0xf bank_mask:0xf
    v_mov_b32 v7, v28
    s_nop 1
    v_permlane16_swap_b32 v7, v28
    v_max_f32 v28, v28, v7
    v_mov_b32 v7, v28
    s_nop 1
    v_permlane32_swap_b32 v7, v28
    v_max_f32 v28, v28, v7
    v_mul_f32 v28, v28, v69
    s_lshl_b32 s36, s6, 2
    s_add_u32 s36, s36, 161792
    v_mov_b32 v4, s36
    ds_write_b32 v4, v28
    s_waitcnt vmcnt(8) lgkmcnt(0)
    s_barrier
    v_mov_b32 v4, 161792
    ds_read_b128 v[120:123], v4
    ds_read_b128 v[16:19], v248 offset:0
    ds_read_b128 v[20:23], v248 offset:1024
    s_waitcnt lgkmcnt(1)
    v_mfma_f32_32x32x16_bf16 v[40:55], v[16:19], v[8:11], 0
    v_max3_f32 v120, v120, v121, v122
    v_max_f32 v120, v120, v123
    v_cmp_nge_f32 vcc, 0x44800000, v120
    s_nop 0
    s_cmp_lg_u64 vcc, 0
    s_cbranch_scc1 L_slow
    v_add_u32 v248, 0xfffff800, v248
    s_waitcnt lgkmcnt(0)
    v_mfma_f32_32x32x16_bf16 v[56:71], v[20:23], v[12:15], 0
    s_nop 3
    v_exp_f32 v40, v40
    ds_read_b64_tr_b16 v[24:25], v249 offset:0
    s_nop 1
    v_exp_f32 v41, v41
    ds_read_b64_tr_b16 v[26:27], v250 offset:0
    v_exp_f32 v42, v42
    v_cvt_pk_bf16_f32 v72, v40, v41
    v_exp_f32 v43, v43
    ds_read_b64_tr_b16 v[28:29], v249 offset:512
    v_exp_f32 v44, v44
    v_cvt_pk_bf16_f32 v73, v42, v43
    v_exp_f32 v45, v45
    ds_read_b64_tr_b16 v[30:31], v250 offset:512
    v_exp_f32 v46, v46
    v_cvt_pk_bf16_f32 v74, v44, v45
    v_exp_f32 v47, v47
    ds_read_b128 v[16:19], v248 offset:0
    v_exp_f32 v48, v48
    v_cvt_pk_bf16_f32 v75, v46, v47
    v_exp_f32 v49, v49
    v_exp_f32 v50, v50
    v_cvt_pk_bf16_f32 v76, v48, v49
    v_exp_f32 v51, v51
    v_exp_f32 v52, v52
    v_cvt_pk_bf16_f32 v77, v50, v51
    v_exp_f32 v53, v53
    v_exp_f32 v54, v54
    v_cvt_pk_bf16_f32 v78, v52, v53
    v_exp_f32 v55, v55
    s_nop 0
    v_cvt_pk_bf16_f32 v79, v54, v55
    v_bfi_b32 v72, v240, 0, v72
    v_bfi_b32 v73, v241, 0, v73
    v_bfi_b32 v74, v242, 0, v74
    v_bfi_b32 v75, v243, 0, v75
    v_bfi_b32 v76, v244, 0, v76
    v_bfi_b32 v77, v245, 0, v77
    v_bfi_b32 v78, v246, 0, v78
    v_bfi_b32 v79, v247, 0, v79
    s_waitcnt lgkmcnt(0)
    v_mfma_f32_32x32x16_bf16 v[40:55], v[16:19], v[8:11], 0
    v_exp_f32 v56, v56
    ds_read_b64_tr_b16 v[32:33], v249 offset:1024
    v_exp_f32 v57, v57
    ds_read_b64_tr_b16 v[34:35], v250 offset:1024
    v_exp_f32 v58, v58
    v_cvt_pk_bf16_f32 v80, v56, v57
    v_exp_f32 v59, v59
    ds_read_b64_tr_b16 v[36:37], v249 offset:1536
    v_exp_f32 v60, v60
    v_cvt_pk_bf16_f32 v81, v58, v59
    v_mfma_f32_32x32x16_bf16 v[88:103], v[24:27], v[72:75], 0
    v_exp_f32 v61, v61
    ds_read_b64_tr_b16 v[38:39], v250 offset:1536
    v_exp_f32 v62, v62
    v_cvt_pk_bf16_f32 v82, v60, v61
    v_exp_f32 v63, v63
    ds_read_b128 v[20:23], v248 offset:1024
    v_exp_f32 v64, v64
    v_cvt_pk_bf16_f32 v83, v62, v63
    v_mfma_f32_32x32x16_bf16 v[88:103], v[28:31], v[76:79], v[88:103]
    v_exp_f32 v65, v65
    v_add_u32 v248, 0xfffff800, v248
    v_exp_f32 v66, v66
    v_cvt_pk_bf16_f32 v84, v64, v65
    v_exp_f32 v67, v67
    v_add_u32 v249, v251, v249
    v_exp_f32 v68, v68
    v_cvt_pk_bf16_f32 v85, v66, v67
    v_exp_f32 v69, v69
    v_add_u32 v250, v251, v250
    v_exp_f32 v70, v70
    v_cvt_pk_bf16_f32 v86, v68, v69
    v_exp_f32 v71, v71
    s_nop 0
    v_cvt_pk_bf16_f32 v87, v70, v71
    v_bfi_b32 v80, v240, 0, v80
    v_bfi_b32 v81, v241, 0, v81
    v_bfi_b32 v82, v242, 0, v82
    v_bfi_b32 v83, v243, 0, v83
    v_bfi_b32 v84, v244, 0, v84
    v_bfi_b32 v85, v245, 0, v85
    v_bfi_b32 v86, v246, 0, v86
    v_bfi_b32 v87, v247, 0, v87
    s_waitcnt lgkmcnt(0)
    v_mfma_f32_32x32x16_bf16 v[56:71], v[20:23], v[12:15], 0
    v_exp_f32 v40, v40
    ds_read_b64_tr_b16 v[24:25], v249 offset:0
    v_exp_f32 v41, v41
    ds_read_b64_tr_b16 v[26:27], v250 offset:0
    v_exp_f32 v42, v42
    v_cvt_pk_bf16_f32 v72, v40, v41
    v_exp_f32 v43, v43
    ds_read_b64_tr_b16 v[28:29], v249 offset:512
    v_exp_f32 v44, v44
    v_cvt_pk_bf16_f32 v73, v42, v43
    v_mfma_f32_32x32x16_bf16 v[104:119], v[32:35], v[80:83], 0
    v_exp_f32 v45, v45
    ds_read_b64_tr_b16 v[30:31], v250 offset:512
    v_exp_f32 v46, v46
    v_cvt_pk_bf16_f32 v74, v44, v45
    v_exp_f32 v47, v47
    ds_read_b128 v[16:19], v248 offset:0
    v_exp_f32 v48, v48
    v_cvt_pk_bf16_f32 v75, v46, v47
    v_mfma_f32_32x32x16_bf16 v[104:119], v[36:39], v[84:87], v[104:119]
    v_exp_f32 v49, v49
    s_add_u32 m0, s72, 65536
    s_add_u32 s68, s68, 16384
    buffer_load_dwordx4 v252, s[24:27], s68 offen lds
    v_exp_f32 v50, v50
    v_cvt_pk_bf16_f32 v76, v48, v49
    v_exp_f32 v51, v51
    s_add_u32 m0, s72, 67584
    s_add_u32 s68, s68, 16384
    buffer_load_dwordx4 v252, s[24:27], s68 offen lds
    v_exp_f32 v52, v52
    v_cvt_pk_bf16_f32 v77, v50, v51
    v_exp_f32 v53, v53
    s_add_u32 m0, s72, 69632
    s_add_u32 s68, s68, 16384
    buffer_load_dwordx4 v252, s[24:27], s68 offen lds
    v_exp_f32 v54, v54
    v_cvt_pk_bf16_f32 v78, v52, v53
    v_exp_f32 v55, v55
    s_nop 0
    v_cvt_pk_bf16_f32 v79, v54, v55
    s_waitcnt lgkmcnt(0)
    v_mfma_f32_32x32x16_bf16 v[40:55], v[16:19], v[8:11], 0
    v_exp_f32 v56, v56
    ds_read_b64_tr_b16 v[32:33], v249 offset:1024
    v_exp_f32 v57, v57
    ds_read_b64_tr_b16 v[34:35], v250 offset:1024
    v_exp_f32 v58, v58
    v_cvt_pk_bf16_f32 v80, v56, v57
    v_exp_f32 v59, v59
    ds_read_b64_tr_b16 v[36:37], v249 offset:1536
    v_exp_f32 v60, v60
    v_cvt_pk_bf16_f32 v81, v58, v59
    v_mfma_f32_32x32x16_bf16 v[88:103], v[24:27], v[72:75], v[88:103]
    v_exp_f32 v61, v61
    ds_read_b64_tr_b16 v[38:39], v250 offset:1536
    v_exp_f32 v62, v62
    v_cvt_pk_bf16_f32 v82, v60, v61
    v_exp_f32 v63, v63
    ds_read_b128 v[20:23], v248 offset:1024
    v_exp_f32 v64, v64
    v_cvt_pk_bf16_f32 v83, v62, v63
    v_mfma_f32_32x32x16_bf16 v[88:103], v[28:31], v[76:79], v[88:103]
    v_exp_f32 v65, v65
    v_add_u32 v248, 0xfffff800, v248
    v_exp_f32 v66, v66
    v_cvt_pk_bf16_f32 v84, v64, v65
    v_exp_f32 v67, v67
    v_add_u32 v249, v251, v249
    v_exp_f32 v68, v68
    v_cvt_pk_bf16_f32 v85, v66, v67
    v_exp_f32 v69, v69
    v_add_u32 v250, v251, v250
    v_exp_f32 v70, v70
    v_cvt_pk_bf16_f32 v86, v68, v69
    v_exp_f32 v71, v71
    s_lshl_b32 s36, s2, 2
    s_add_u32 s36, s36, s6
    s_lshr_b32 s37, s36, 9
    s_mul_i32 s37, s37, 896
    s_and_b32 s36, s36, 511
    s_add_u32 s36, s36, s37
    s_lshl_b32 s36, s36, 10
    s_add_u32 s36, s36, 384
    v_mov_b32 v2, 0
    s_mov_b64 exec, 1
    buffer_load_dword v126, v2, s[24:27], s36 offen
    s_mov_b64 exec, -1
    v_cvt_pk_bf16_f32 v87, v70, v71
    s_add_u32 m0, s72, 71680
    s_add_u32 s68, s68, 16384
    buffer_load_dwordx4 v252, s[24:27], s68 offen lds
    s_add_u32 m0, s72, 81920
    s_add_u32 s68, s68, 16384
    buffer_load_dwordx4 v252, s[24:27], s68 offen lds
    s_add_u32 m0, s72, 83968
    s_add_u32 s68, s68, 16384
    buffer_load_dwordx4 v252, s[24:27], s68 offen lds
    s_waitcnt lgkmcnt(0)
    v_mfma_f32_32x32x16_bf16 v[56:71], v[20:23], v[12:15], 0
    v_exp_f32 v40, v40
    ds_read_b64_tr_b16 v[24:25], v249 offset:0
    v_exp_f32 v41, v41
    ds_read_b64_tr_b16 v[26:27], v250 offset:0
    v_exp_f32 v42, v42
    v_cvt_pk_bf16_f32 v72, v40, v41
    v_exp_f32 v43, v43
    ds_read_b64_tr_b16 v[28:29], v249 offset:512
    v_exp_f32 v44, v44
    v_cvt_pk_bf16_f32 v73, v42, v43
    v_mfma_f32_32x32x16_bf16 v[104:119], v[32:35], v[80:83], v[104:119]
    v_exp_f32 v45, v45
    ds_read_b64_tr_b16 v[30:31], v250 offset:512
    v_exp_f32 v46, v46
    v_cvt_pk_bf16_f32 v74, v44, v45
    v_exp_f32 v47, v47
    ds_read_b128 v[16:19], v248 offset:0
    v_exp_f32 v48, v48
    v_cvt_pk_bf16_f32 v75, v46, v47
    v_mfma_f32_32x32x16_bf16 v[104:119], v[36:39], v[84:87], v[104:119]
    v_exp_f32 v49, v49
    s_add_u32 m0, s72, 86016
    s_add_u32 s68, s68, 16384
    buffer_load_dwordx4 v252, s[24:27], s68 offen lds
    v_exp_f32 v50, v50
    v_cvt_pk_bf16_f32 v76, v48, v49
    v_exp_f32 v51, v51
    s_add_u32 m0, s72, 88064
    s_add_u32 s68, s68, 16384
    buffer_load_dwordx4 v252, s[24:27], s68 offen lds
    v_exp_f32 v52, v52
    v_cvt_pk_bf16_f32 v77, v50, v51
    v_exp_f32 v53, v53
    s_add_u32 m0, s72, 98304
    s_add_u32 s68, s68, 16384
    buffer_load_dwordx4 v252, s[24:27], s68 offen lds
    v_exp_f32 v54, v54
    v_cvt_pk_bf16_f32 v78, v52, v53
    v_exp_f32 v55, v55
    s_nop 0
    v_cvt_pk_bf16_f32 v79, v54, v55
    s_waitcnt lgkmcnt(0)
    v_mfma_f32_32x32x16_bf16 v[40:55], v[16:19], v[8:11], 0
    v_exp_f32 v56, v56
    ds_read_b64_tr_b16 v[32:33], v249 offset:1024
    v_exp_f32 v57, v57
    ds_read_b64_tr_b16 v[34:35], v250 offset:1024
    v_exp_f32 v58, v58
    v_cvt_pk_bf16_f32 v80, v56, v57
    v_exp_f32 v59, v59
    ds_read_b64_tr_b16 v[36:37], v249 offset:1536
    v_exp_f32 v60, v60
    v_cvt_pk_bf16_f32 v81, v58, v59
    v_mfma_f32_32x32x16_bf16 v[88:103], v[24:27], v[72:75], v[88:103]
    v_exp_f32 v61, v61
    ds_read_b64_tr_b16 v[38:39], v250 offset:1536
    v_exp_f32 v62, v62
    v_cvt_pk_bf16_f32 v82, v60, v61
    v_exp_f32 v63, v63
    ds_read_b128 v[20:23], v248 offset:1024
    v_exp_f32 v64, v64
    v_cvt_pk_bf16_f32 v83, v62, v63
    v_mfma_f32_32x32x16_bf16 v[88:103], v[28:31], v[76:79], v[88:103]
    v_exp_f32 v65, v65
    v_add_u32 v248, 0xfffff800, v248
    v_exp_f32 v66, v66
    v_cvt_pk_bf16_f32 v84, v64, v65
    v_exp_f32 v67, v67
    v_add_u32 v249, v251, v249
    v_exp_f32 v68, v68
    v_cvt_pk_bf16_f32 v85, v66, v67
    v_exp_f32 v69, v69
    v_add_u32 v250, v251, v250
    v_exp_f32 v70, v70
    v_cvt_pk_bf16_f32 v86, v68, v69
    v_exp_f32 v71, v71
    s_add_u32 m0, s72, 100352
    s_add_u32 s68, s68, 16384
    buffer_load_dwordx4 v252, s[24:27], s68 offen lds
    v_cvt_pk_bf16_f32 v87, v70, v71
    s_add_u32 m0, s72, 102400
    s_add_u32 s68, s68, 16384
    buffer_load_dwordx4 v252, s[24:27], s68 offen lds
    s_add_u32 m0, s72, 104448
    s_add_u32 s68, s68, 16384
    buffer_load_dwordx4 v252, s[24:27], s68 offen lds
    s_waitcnt lgkmcnt(0)
    v_mfma_f32_32x32x16_bf16 v[56:71], v[20:23], v[12:15], 0
    v_exp_f32 v40, v40
    ds_read_b64_tr_b16 v[24:25], v249 offset:0
    v_exp_f32 v41, v41
    ds_read_b64_tr_b16 v[26:27], v250 offset:0
    v_exp_f32 v42, v42
    v_cvt_pk_bf16_f32 v72, v40, v41
    v_exp_f32 v43, v43
    ds_read_b64_tr_b16 v[28:29], v249 offset:512
    v_exp_f32 v44, v44
    v_cvt_pk_bf16_f32 v73, v42, v43
    v_mfma_f32_32x32x16_bf16 v[104:119], v[32:35], v[80:83], v[104:119]
    v_exp_f32 v45, v45
    ds_read_b64_tr_b16 v[30:31], v250 offset:512
    v_exp_f32 v46, v46
    v_cvt_pk_bf16_f32 v74, v44, v45
    v_exp_f32 v47, v47
    ds_read_b128 v[16:19], v248 offset:0
    v_exp_f32 v48, v48
    v_cvt_pk_bf16_f32 v75, v46, v47
    v_mfma_f32_32x32x16_bf16 v[104:119], v[36:39], v[84:87], v[104:119]
    v_exp_f32 v49, v49
    s_add_u32 m0, s72, 114688
    s_add_u32 s68, s68, 16384
    buffer_load_dwordx4 v252, s[24:27], s68 offen lds
    v_exp_f32 v50, v50
    v_cvt_pk_bf16_f32 v76, v48, v49
    v_exp_f32 v51, v51
    s_add_u32 m0, s72, 116736
    s_add_u32 s68, s68, 16384
    buffer_load_dwordx4 v252, s[24:27], s68 offen lds
    v_exp_f32 v52, v52
    v_cvt_pk_bf16_f32 v77, v50, v51
    v_exp_f32 v53, v53
    v_exp_f32 v54, v54
    v_cvt_pk_bf16_f32 v78, v52, v53
    v_exp_f32 v55, v55
    s_nop 0
    v_cvt_pk_bf16_f32 v79, v54, v55
    s_waitcnt lgkmcnt(0)
    v_mfma_f32_32x32x16_bf16 v[40:55], v[16:19], v[8:11], 0
    v_exp_f32 v56, v56
    ds_read_b64_tr_b16 v[32:33], v249 offset:1024
    v_exp_f32 v57, v57
    ds_read_b64_tr_b16 v[34:35], v250 offset:1024
    v_exp_f32 v58, v58
    v_cvt_pk_bf16_f32 v80, v56, v57
    v_exp_f32 v59, v59
    ds_read_b64_tr_b16 v[36:37], v249 offset:1536
    v_exp_f32 v60, v60
    v_cvt_pk_bf16_f32 v81, v58, v59
    v_mfma_f32_32x32x16_bf16 v[88:103], v[24:27], v[72:75], v[88:103]
    v_exp_f32 v61, v61
    ds_read_b64_tr_b16 v[38:39], v250 offset:1536
    v_exp_f32 v62, v62
    v_cvt_pk_bf16_f32 v82, v60, v61
    v_exp_f32 v63, v63
    ds_read_b128 v[20:23], v248 offset:1024
    v_exp_f32 v64, v64
    v_cvt_pk_bf16_f32 v83, v62, v63
    v_mfma_f32_32x32x16_bf16 v[88:103], v[28:31], v[76:79], v[88:103]
    v_exp_f32 v65, v65
    v_add_u32 v248, 0xfffff800, v248
    v_exp_f32 v66, v66
    v_cvt_pk_bf16_f32 v84, v64, v65
    v_exp_f32 v67, v67
    v_add_u32 v249, v251, v249
    v_exp_f32 v68, v68
    v_cvt_pk_bf16_f32 v85, v66, v67
    v_exp_f32 v69, v69
    v_add_u32 v250, v251, v250
    v_exp_f32 v70, v70
    v_cvt_pk_bf16_f32 v86, v68, v69
    v_exp_f32 v71, v71
    s_add_u32 m0, s72, 118784
    s_add_u32 s68, s68, 16384
    buffer_load_dwordx4 v252, s[24:27], s68 offen lds
    v_cvt_pk_bf16_f32 v87, v70, v71
    s_add_u32 m0, s72, 120832
    s_add_u32 s68, s68, 16384
    buffer_load_dwordx4 v252, s[24:27], s68 offen lds
    s_waitcnt lgkmcnt(0)
    v_mfma_f32_32x32x16_bf16 v[56:71], v[20:23], v[12:15], 0
    v_exp_f32 v40, v40
    ds_read_b64_tr_b16 v[24:25], v249 offset:0
    v_exp_f32 v41, v41
    ds_read_b64_tr_b16 v[26:27], v250 offset:0
    v_exp_f32 v42, v42
    v_cvt_pk_bf16_f32 v72, v40, v41
    v_exp_f32 v43, v43
    ds_read_b64_tr_b16 v[28:29], v249 offset:512
    v_exp_f32 v44, v44
    v_cvt_pk_bf16_f32 v73, v42, v43
    v_mfma_f32_32x32x16_bf16 v[104:119], v[32:35], v[80:83], v[104:119]
    v_exp_f32 v45, v45
    ds_read_b64_tr_b16 v[30:31], v250 offset:512
    v_exp_f32 v46, v46
    v_cvt_pk_bf16_f32 v74, v44, v45
    v_exp_f32 v47, v47
    ds_read_b128 v[16:19], v248 offset:0
    v_exp_f32 v48, v48
    v_cvt_pk_bf16_f32 v75, v46, v47
    v_mfma_f32_32x32x16_bf16 v[104:119], v[36:39], v[84:87], v[104:119]
    v_exp_f32 v49, v49
    v_exp_f32 v50, v50
    v_cvt_pk_bf16_f32 v76, v48, v49
    v_exp_f32 v51, v51
    v_exp_f32 v52, v52
    v_cvt_pk_bf16_f32 v77, v50, v51
    v_exp_f32 v53, v53
    v_exp_f32 v54, v54
    v_cvt_pk_bf16_f32 v78, v52, v53
    v_exp_f32 v55, v55
    s_nop 0
    v_cvt_pk_bf16_f32 v79, v54, v55
    s_waitcnt lgkmcnt(0)
    v_mfma_f32_32x32x16_bf16 v[40:55], v[16:19], v[8:11], 0
    v_exp_f32 v56, v56
    ds_read_b64_tr_b16 v[32:33], v249 offset:1024
    v_exp_f32 v57, v57
    ds_read_b64_tr_b16 v[34:35], v250 offset:1024
    v_exp_f32 v58, v58
    v_cvt_pk_bf16_f32 v80, v56, v57
    v_exp_f32 v59, v59
    ds_read_b64_tr_b16 v[36:37], v249 offset:1536
    v_exp_f32 v60, v60
    v_cvt_pk_bf16_f32 v81, v58, v59
    v_mfma_f32_32x32x16_bf16 v[88:103], v[24:27], v[72:75], v[88:103]
    v_exp_f32 v61, v61
    ds_read_b64_tr_b16 v[38:39], v250 offset:1536
    v_exp_f32 v62, v62
    v_cvt_pk_bf16_f32 v82, v60, v61
    v_exp_f32 v63, v63
    ds_read_b128 v[20:23], v248 offset:1024
    v_exp_f32 v64, v64
    v_cvt_pk_bf16_f32 v83, v62, v63
    v_mfma_f32_32x32x16_bf16 v[88:103], v[28:31], v[76:79], v[88:103]
    v_exp_f32 v65, v65
    v_add_u32 v248, 0xfffff800, v248
    v_exp_f32 v66, v66
    v_cvt_pk_bf16_f32 v84, v64, v65
    v_exp_f32 v67, v67
    v_add_u32 v249, v251, v249
    v_exp_f32 v68, v68
    v_cvt_pk_bf16_f32 v85, v66, v67
    v_exp_f32 v69, v69
    v_add_u32 v250, v251, v250
    v_exp_f32 v70, v70
    v_cvt_pk_bf16_f32 v86, v68, v69
    v_exp_f32 v71, v71
    s_waitcnt vmcnt(17)
    s_add_u32 s36, s101, 17836032
    v_mov_b32 v3, s47
    v_mov_b32 v2, 0
    s_mov_b64 exec, 1
    buffer_store_dword v3, v2, s[32:35], s36 offen sc1
    s_mov_b64 exec, -1
    v_cvt_pk_bf16_f32 v87, v70, v71
    s_waitcnt lgkmcnt(0)
    v_mfma_f32_32x32x16_bf16 v[56:71], v[20:23], v[12:15], 0
    v_exp_f32 v40, v40
    ds_read_b64_tr_b16 v[24:25], v249 offset:0
    v_exp_f32 v41, v41
    ds_read_b64_tr_b16 v[26:27], v250 offset:0
    v_exp_f32 v42, v42
    v_cvt_pk_bf16_f32 v72, v40, v41
    v_exp_f32 v43, v43
    ds_read_b64_tr_b16 v[28:29], v249 offset:512
    v_exp_f32 v44, v44
    v_cvt_pk_bf16_f32 v73, v42, v43
    v_mfma_f32_32x32x16_bf16 v[104:119], v[32:35], v[80:83], v[104:119]
    v_exp_f32 v45, v45
    ds_read_b64_tr_b16 v[30:31], v250 offset:512
    v_exp_f32 v46, v46
    v_cvt_pk_bf16_f32 v74, v44, v45
    v_exp_f32 v47, v47
    ds_read_b128 v[16:19], v248 offset:0
    v_exp_f32 v48, v48
    v_cvt_pk_bf16_f32 v75, v46, v47
    v_mfma_f32_32x32x16_bf16 v[104:119], v[36:39], v[84:87], v[104:119]
    v_exp_f32 v49, v49
    v_and_b32 v2, 31, v1
    s_lshl_b32 s36, s66, 5
    v_add_u32 v2, s36, v2
    v_lshlrev_b32 v3, 4, v2
    buffer_load_dwordx4 v[236:239], v3, s[32:35], 0 offen offset:0 sc1
    v_lshlrev_b32 v2, 10, v2
    v_lshrrev_b32 v3, 5, v1
    v_lshl_add_u32 v3, v3, 3, v2
    s_lshl_b32 s36, s67, 7
    s_lshl_b32 s37, s65, 6
    s_add_u32 s73, s36, s37
    buffer_load_dwordx2 v[224:225], v3, s[8:11], s73 offen offset:0
    buffer_load_dwordx2 v[226:227], v3, s[8:11], s73 offen offset:16
    buffer_load_dwordx2 v[228:229], v3, s[8:11], s73 offen offset:32
    buffer_load_dwordx2 v[230:231], v3, s[8:11], s73 offen offset:48
    v_exp_f32 v50, v50
    v_cvt_pk_bf16_f32 v76, v48, v49
    v_exp_f32 v51, v51
    v_exp_f32 v52, v52
    v_cvt_pk_bf16_f32 v77, v50, v51
    v_exp_f32 v53, v53
    v_exp_f32 v54, v54
    v_cvt_pk_bf16_f32 v78, v52, v53
    v_exp_f32 v55, v55
    s_nop 0
    v_cvt_pk_bf16_f32 v79, v54, v55
    s_waitcnt lgkmcnt(0)
    v_mfma_f32_32x32x16_bf16 v[40:55], v[16:19], v[8:11], 0
    v_exp_f32 v56, v56
    ds_read_b64_tr_b16 v[32:33], v249 offset:1024
    v_exp_f32 v57, v57
    ds_read_b64_tr_b16 v[34:35], v250 offset:1024
    v_exp_f32 v58, v58
    v_cvt_pk_bf16_f32 v80, v56, v57
    v_exp_f32 v59, v59
    ds_read_b64_tr_b16 v[36:37], v249 offset:1536
    v_exp_f32 v60, v60
    v_cvt_pk_bf16_f32 v81, v58, v59
    v_mfma_f32_32x32x16_bf16 v[88:103], v[24:27], v[72:75], v[88:103]
    v_exp_f32 v61, v61
    ds_read_b64_tr_b16 v[38:39], v250 offset:1536
    v_exp_f32 v62, v62
    v_cvt_pk_bf16_f32 v82, v60, v61
    v_exp_f32 v63, v63
    ds_read_b128 v[20:23], v248 offset:1024
    v_exp_f32 v64, v64
    v_cvt_pk_bf16_f32 v83, v62, v63
    v_mfma_f32_32x32x16_bf16 v[88:103], v[28:31], v[76:79], v[88:103]
    v_exp_f32 v65, v65
    v_add_u32 v248, 0xfffff800, v248
    v_exp_f32 v66, v66
    v_cvt_pk_bf16_f32 v84, v64, v65
    v_exp_f32 v67, v67
    v_add_u32 v249, v251, v249
    v_exp_f32 v68, v68
    v_cvt_pk_bf16_f32 v85, v66, v67
    v_exp_f32 v69, v69
    v_add_u32 v250, v251, v250
    v_exp_f32 v70, v70
    v_cvt_pk_bf16_f32 v86, v68, v69
    v_exp_f32 v71, v71
    s_waitcnt vmcnt(5)
    s_barrier
    s_lshl_b32 s36, s65, 6
    v_xor_b32 v192, s36, v254
    v_xor_b32 v193, 64, v192
    v_add_u32 v194, 0x10000, v192
    v_add_u32 v195, 0x10000, v193
    v_add_u32 v196, 0x20000, v192
    v_add_u32 v197, 0x20000, v193
    v_cvt_pk_bf16_f32 v87, v70, v71
    ds_read_b64_tr_b16 v[128:129], v192 offset:49152
    ds_read_b64_tr_b16 v[130:131], v192 offset:50176
    ds_read_b64_tr_b16 v[132:133], v193 offset:49152
    ds_read_b64_tr_b16 v[134:135], v193 offset:50176
    ds_read_b64_tr_b16 v[136:137], v192 offset:51200
    ds_read_b64_tr_b16 v[138:139], v192 offset:52224
    ds_read_b64_tr_b16 v[140:141], v193 offset:51200
    ds_read_b64_tr_b16 v[142:143], v193 offset:52224
    ds_read_b64_tr_b16 v[144:145], v192 offset:53248
    ds_read_b64_tr_b16 v[146:147], v192 offset:54272
    ds_read_b64_tr_b16 v[148:149], v193 offset:53248
    ds_read_b64_tr_b16 v[150:151], v193 offset:54272
    ds_read_b64_tr_b16 v[152:153], v192 offset:55296
    ds_read_b64_tr_b16 v[154:155], v192 offset:56320
    ds_read_b64_tr_b16 v[156:157], v193 offset:55296
    ds_read_b64_tr_b16 v[158:159], v193 offset:56320
    s_waitcnt lgkmcnt(0)
    v_mfma_f32_32x32x16_bf16 v[56:71], v[20:23], v[12:15], 0
    v_exp_f32 v40, v40
    ds_read_b64_tr_b16 v[24:25], v249 offset:0
    v_exp_f32 v41, v41
    ds_read_b64_tr_b16 v[26:27], v250 offset:0
    v_exp_f32 v42, v42
    v_cvt_pk_bf16_f32 v72, v40, v41
    v_exp_f32 v43, v43
    ds_read_b64_tr_b16 v[28:29], v249 offset:512
    v_exp_f32 v44, v44
    v_cvt_pk_bf16_f32 v73, v42, v43
    v_mfma_f32_32x32x16_bf16 v[104:119], v[32:35], v[80:83], v[104:119]
    v_exp_f32 v45, v45
    ds_read_b64_tr_b16 v[30:31], v250 offset:512
    v_exp_f32 v46, v46
    v_cvt_pk_bf16_f32 v74, v44, v45
    v_exp_f32 v47, v47
    ds_read_b128 v[16:19], v248 offset:0
    v_exp_f32 v48, v48
    v_cvt_pk_bf16_f32 v75, v46, v47
    v_mfma_f32_32x32x16_bf16 v[104:119], v[36:39], v[84:87], v[104:119]
    v_exp_f32 v49, v49
    s_lshl_b32 s36, s98, 8
    s_add_u32 s36, s36, 17836032
    v_lshlrev_b32 v2, 2, v1
    buffer_load_dword v124, v2, s[32:35], s36 offen sc1
    v_exp_f32 v50, v50
    v_cvt_pk_bf16_f32 v76, v48, v49
    v_exp_f32 v51, v51
    ds_read_b64_tr_b16 v[160:161], v196 offset:0
    v_exp_f32 v52, v52
    v_cvt_pk_bf16_f32 v77, v50, v51
    v_exp_f32 v53, v53
    ds_read_b64_tr_b16 v[162:163], v196 offset:1024
    v_exp_f32 v54, v54
    v_cvt_pk_bf16_f32 v78, v52, v53
    v_exp_f32 v55, v55
    ds_read_b64_tr_b16 v[164:165], v197 offset:0
    v_cvt_pk_bf16_f32 v79, v54, v55
    ds_read_b64_tr_b16 v[166:167], v197 offset:1024
    ds_read_b64_tr_b16 v[168:169], v196 offset:2048
    ds_read_b64_tr_b16 v[170:171], v196 offset:3072
    ds_read_b64_tr_b16 v[172:173], v197 offset:2048
    ds_read_b64_tr_b16 v[174:175], v197 offset:3072
    ds_read_b64_tr_b16 v[176:177], v196 offset:4096
    ds_read_b64_tr_b16 v[178:179], v196 offset:5120
    ds_read_b64_tr_b16 v[180:181], v197 offset:4096
    ds_read_b64_tr_b16 v[182:183], v197 offset:5120
    ds_read_b64_tr_b16 v[184:185], v196 offset:6144
    ds_read_b64_tr_b16 v[186:187], v196 offset:7168
    ds_read_b64_tr_b16 v[188:189], v197 offset:6144
    ds_read_b64_tr_b16 v[190:191], v197 offset:7168
    s_waitcnt lgkmcnt(0)
    v_mfma_f32_32x32x16_bf16 v[40:55], v[16:19], v[8:11], 0
    v_exp_f32 v56, v56
    ds_read_b64_tr_b16 v[32:33], v249 offset:1024
    v_exp_f32 v57, v57
    ds_read_b64_tr_b16 v[34:35], v250 offset:1024
    v_exp_f32 v58, v58
    v_cvt_pk_bf16_f32 v80, v56, v57
    v_exp_f32 v59, v59
    ds_read_b64_tr_b16 v[36:37], v249 offset:1536
    v_exp_f32 v60, v60
    v_cvt_pk_bf16_f32 v81, v58, v59
    v_mfma_f32_32x32x16_bf16 v[88:103], v[24:27], v[72:75], v[88:103]
    v_exp_f32 v61, v61
    ds_read_b64_tr_b16 v[38:39], v250 offset:1536
    v_exp_f32 v62, v62
    v_cvt_pk_bf16_f32 v82, v60, v61
    v_exp_f32 v63, v63
    ds_read_b128 v[20:23], v248 offset:1024
    v_exp_f32 v64, v64
    v_cvt_pk_bf16_f32 v83, v62, v63
    v_mfma_f32_32x32x16_bf16 v[88:103], v[28:31], v[76:79], v[88:103]
    v_exp_f32 v65, v65
    v_add_u32 v248, 0xfffff800, v248
    v_exp_f32 v66, v66
    v_cvt_pk_bf16_f32 v84, v64, v65
    v_exp_f32 v67, v67
    v_add_u32 v249, v251, v249
    v_exp_f32 v68, v68
    v_cvt_pk_bf16_f32 v85, v66, v67
    v_exp_f32 v69, v69
    v_add_u32 v250, v251, v250
    v_exp_f32 v70, v70
    v_cvt_pk_bf16_f32 v86, v68, v69
    v_exp_f32 v71, v71
    s_nop 0
    v_cvt_pk_bf16_f32 v87, v70, v71
    s_waitcnt lgkmcnt(0)
    v_mfma_f32_32x32x16_bf16 v[56:71], v[20:23], v[12:15], 0
    v_exp_f32 v40, v40
    ds_read_b64_tr_b16 v[24:25], v249 offset:0
    v_exp_f32 v41, v41
    ds_read_b64_tr_b16 v[26:27], v250 offset:0
    v_exp_f32 v42, v42
    v_cvt_pk_bf16_f32 v72, v40, v41
    v_exp_f32 v43, v43
    ds_read_b64_tr_b16 v[28:29], v249 offset:512
    v_exp_f32 v44, v44
    v_cvt_pk_bf16_f32 v73, v42, v43
    v_mfma_f32_32x32x16_bf16 v[104:119], v[32:35], v[80:83], v[104:119]
    v_exp_f32 v45, v45
    ds_read_b64_tr_b16 v[30:31], v250 offset:512
    v_exp_f32 v46, v46
    v_cvt_pk_bf16_f32 v74, v44, v45
    v_exp_f32 v47, v47
    ds_read_b128 v[16:19], v248 offset:0
    v_exp_f32 v48, v48
    v_cvt_pk_bf16_f32 v75, v46, v47
    v_mfma_f32_32x32x16_bf16 v[104:119], v[36:39], v[84:87], v[104:119]
    v_exp_f32 v49, v49
    s_waitcnt lgkmcnt(0)
    s_barrier
    v_exp_f32 v50, v50
    v_cvt_pk_bf16_f32 v76, v48, v49
    v_exp_f32 v51, v51
    s_add_u32 m0, s72, 49152
    s_add_u32 s68, s68, 16384
    buffer_load_dwordx4 v252, s[24:27], s68 offen lds
    v_exp_f32 v52, v52
    v_cvt_pk_bf16_f32 v77, v50, v51
    v_exp_f32 v53, v53
    s_add_u32 m0, s72, 51200
    s_add_u32 s68, s68, 16384
    buffer_load_dwordx4 v252, s[24:27], s68 offen lds
    v_exp_f32 v54, v54
    v_cvt_pk_bf16_f32 v78, v52, v53
    v_exp_f32 v55, v55
    s_add_u32 m0, s72, 53248
    s_add_u32 s68, s68, 16384
    buffer_load_dwordx4 v252, s[24:27], s68 offen lds
    v_cvt_pk_bf16_f32 v79, v54, v55
    s_add_u32 m0, s72, 55296
    s_add_u32 s68, s68, 16384
    buffer_load_dwordx4 v252, s[24:27], s68 offen lds
    s_add_u32 m0, s72, 131072
    s_add_u32 s68, s68, 16384
    buffer_load_dwordx4 v252, s[24:27], s68 offen lds
    s_add_u32 m0, s72, 133120
    s_add_u32 s68, s68, 16384
    buffer_load_dwordx4 v252, s[24:27], s68 offen lds
    s_add_u32 m0, s72, 135168
    s_add_u32 s68, s68, 16384
    buffer_load_dwordx4 v252, s[24:27], s68 offen lds
    s_add_u32 m0, s72, 137216
    s_add_u32 s68, s68, 16384
    buffer_load_dwordx4 v252, s[24:27], s68 offen lds
    s_waitcnt lgkmcnt(0)
    v_mfma_f32_32x32x16_bf16 v[40:55], v[16:19], v[8:11], 0
    v_exp_f32 v56, v56
    ds_read_b64_tr_b16 v[32:33], v249 offset:1024
    v_exp_f32 v57, v57
    ds_read_b64_tr_b16 v[34:35], v250 offset:1024
    v_exp_f32 v58, v58
    v_cvt_pk_bf16_f32 v80, v56, v57
    v_exp_f32 v59, v59
    ds_read_b64_tr_b16 v[36:37], v249 offset:1536
    v_exp_f32 v60, v60
    v_cvt_pk_bf16_f32 v81, v58, v59
    v_mfma_f32_32x32x16_bf16 v[88:103], v[24:27], v[72:75], v[88:103]
    v_exp_f32 v61, v61
    ds_read_b64_tr_b16 v[38:39], v250 offset:1536
    v_exp_f32 v62, v62
    v_cvt_pk_bf16_f32 v82, v60, v61
    v_exp_f32 v63, v63
    ds_read_b128 v[20:23], v248 offset:1024
    v_exp_f32 v64, v64
    v_cvt_pk_bf16_f32 v83, v62, v63
    v_mfma_f32_32x32x16_bf16 v[88:103], v[28:31], v[76:79], v[88:103]
    v_exp_f32 v65, v65
    v_add_u32 v248, 0xfffff800, v248
    v_exp_f32 v66, v66
    v_cvt_pk_bf16_f32 v84, v64, v65
    v_exp_f32 v67, v67
    v_add_u32 v249, v251, v249
    v_exp_f32 v68, v68
    v_cvt_pk_bf16_f32 v85, v66, v67
    v_exp_f32 v69, v69
    v_add_u32 v250, v251, v250
    v_exp_f32 v70, v70
    v_cvt_pk_bf16_f32 v86, v68, v69
    v_exp_f32 v71, v71
    s_nop 0
    v_cvt_pk_bf16_f32 v87, v70, v71
    s_waitcnt lgkmcnt(0)
    v_mfma_f32_32x32x16_bf16 v[56:71], v[20:23], v[12:15], 0
    v_exp_f32 v40, v40
    ds_read_b64_tr_b16 v[24:25], v249 offset:0
    v_exp_f32 v41, v41
    ds_read_b64_tr_b16 v[26:27], v250 offset:0
    v_exp_f32 v42, v42
    v_cvt_pk_bf16_f32 v72, v40, v41
    v_exp_f32 v43, v43
    ds_read_b64_tr_b16 v[28:29], v249 offset:512
    v_exp_f32 v44, v44
    v_cvt_pk_bf16_f32 v73, v42, v43
    v_mfma_f32_32x32x16_bf16 v[104:119], v[32:35], v[80:83], v[104:119]
    v_exp_f32 v45, v45
    ds_read_b64_tr_b16 v[30:31], v250 offset:512
    v_exp_f32 v46, v46
    v_cvt_pk_bf16_f32 v74, v44, v45
    v_exp_f32 v47, v47
    v_exp_f32 v48, v48
    v_cvt_pk_bf16_f32 v75, v46, v47
    v_mfma_f32_32x32x16_bf16 v[104:119], v[36:39], v[84:87], v[104:119]
    v_exp_f32 v49, v49
    s_waitcnt vmcnt(8)
    v_cmp_eq_u32 vcc, s47, v124
    s_nop 0
    s_cmp_eq_u64 vcc, -1
    s_cbranch_scc0 L_hp_spin
L_hp_ok:
    v_exp_f32 v50, v50
    v_cvt_pk_bf16_f32 v76, v48, v49
    v_exp_f32 v51, v51
    buffer_load_dwordx4 a[0:3], v253, s[32:35], s70 offen offset:0 sc1
    v_exp_f32 v52, v52
    v_cvt_pk_bf16_f32 v77, v50, v51
    v_exp_f32 v53, v53
    buffer_load_dwordx4 a[4:7], v253, s[32:35], s70 offen offset:1024 sc1
    v_exp_f32 v54, v54
    v_cvt_pk_bf16_f32 v78, v52, v53
    v_exp_f32 v55, v55
    buffer_load_dwordx4 a[8:11], v253, s[32:35], s70 offen offset:2048 sc1
    v_cvt_pk_bf16_f32 v79, v54, v55
    buffer_load_dwordx4 a[12:15], v253, s[32:35], s70 offen offset:3072 sc1
    s_add_u32 s70, s70, 4096
    buffer_load_dwordx4 a[16:19], v253, s[32:35], s70 offen offset:0 sc1
    buffer_load_dwordx4 a[20:23], v253, s[32:35], s70 offen offset:1024 sc1
    v_and_b32 v72, v72, v240
    v_and_b32 v73, v73, v241
    v_and_b32 v74, v74, v242
    v_and_b32 v75, v75, v243
    v_and_b32 v76, v76, v244
    v_and_b32 v77, v77, v245
    v_and_b32 v78, v78, v246
    v_and_b32 v79, v79, v247
    s_waitcnt lgkmcnt(0)
    v_exp_f32 v56, v56
    ds_read_b64_tr_b16 v[32:33], v249 offset:1024
    v_exp_f32 v57, v57
    ds_read_b64_tr_b16 v[34:35], v250 offset:1024
    v_exp_f32 v58, v58
    v_cvt_pk_bf16_f32 v80, v56, v57
    v_exp_f32 v59, v59
    ds_read_b64_tr_b16 v[36:37], v249 offset:1536
    v_exp_f32 v60, v60
    v_cvt_pk_bf16_f32 v81, v58, v59
    v_mfma_f32_32x32x16_bf16 v[88:103], v[24:27], v[72:75], v[88:103]
    v_exp_f32 v61, v61
    ds_read_b64_tr_b16 v[38:39], v250 offset:1536
    v_exp_f32 v62, v62
    v_cvt_pk_bf16_f32 v82, v60, v61
    v_exp_f32 v63, v63
    v_exp_f32 v64, v64
    v_cvt_pk_bf16_f32 v83, v62, v63
    v_mfma_f32_32x32x16_bf16 v[88:103], v[28:31], v[76:79], v[88:103]
    v_exp_f32 v65, v65
    buffer_load_dwordx4 a[24:27], v253, s[32:35], s70 offen offset:2048 sc1
    v_exp_f32 v66, v66
    v_cvt_pk_bf16_f32 v84, v64, v65
    v_exp_f32 v67, v67
    buffer_load_dwordx4 a[28:31], v253, s[32:35], s70 offen offset:3072 sc1
    s_add_u32 s70, s70, 4096
    v_exp_f32 v68, v68
    v_cvt_pk_bf16_f32 v85, v66, v67
    v_exp_f32 v69, v69
    buffer_load_dwordx4 a[32:35], v253, s[32:35], s70 offen offset:0 sc1
    v_exp_f32 v70, v70
    v_cvt_pk_bf16_f32 v86, v68, v69
    v_exp_f32 v71, v71
    buffer_load_dwordx4 a[36:39], v253, s[32:35], s70 offen offset:1024 sc1
    v_cvt_pk_bf16_f32 v87, v70, v71
    buffer_load_dwordx4 a[40:43], v253, s[32:35], s70 offen offset:2048 sc1
    buffer_load_dwordx4 a[44:47], v253, s[32:35], s70 offen offset:3072 sc1
    s_add_u32 s70, s70, 4096
    v_and_b32 v80, v80, v240
    v_and_b32 v81, v81, v241
    v_and_b32 v82, v82, v242
    v_and_b32 v83, v83, v243
    v_and_b32 v84, v84, v244
    v_and_b32 v85, v85, v245
    v_and_b32 v86, v86, v246
    v_and_b32 v87, v87, v247
    s_waitcnt lgkmcnt(0)
    s_nop 1
    v_mfma_f32_32x32x16_bf16 v[104:119], v[32:35], v[80:83], v[104:119]
    v_mfma_f32_32x32x16_bf16 v[104:119], v[36:39], v[84:87], v[104:119]
L_att_fin:
    v_rcp_f32 v2, v96
    s_nop 0
    v_mul_f32 v2, v2, v223
    v_mul_f32 v88, v88, v2
    v_mul_f32 v89, v89, v2
    v_mul_f32 v90, v90, v2
    v_mul_f32 v91, v91, v2
    v_mul_f32 v92, v92, v2
    v_mul_f32 v93, v93, v2
    v_mul_f32 v94, v94, v2
    v_mul_f32 v95, v95, v2
    v_cvt_pk_bf16_f32 v72, v88, v89
    v_cvt_pk_bf16_f32 v73, v90, v91
    v_cvt_pk_bf16_f32 v74, v92, v93
    v_cvt_pk_bf16_f32 v75, v94, v95
    v_rcp_f32 v3, v112
    s_nop 0
    v_mul_f32 v3, v3, v223
    v_mul_f32 v104, v104, v3
    v_mul_f32 v105, v105, v3
    v_mul_f32 v106, v106, v3
    v_mul_f32 v107, v107, v3
    v_mul_f32 v108, v108, v3
    v_mul_f32 v109, v109, v3
    v_mul_f32 v110, v110, v3
    v_mul_f32 v111, v111, v3
    v_cvt_pk_bf16_f32 v76, v104, v105
    v_cvt_pk_bf16_f32 v77, v106, v107
    v_cvt_pk_bf16_f32 v78, v108, v109
    v_cvt_pk_bf16_f32 v79, v110, v111
    s_lshl_b32 s36, s74, 15
    s_lshl_b32 s37, s5, 11
    s_add_u32 s36, s36, s37
    s_add_u32 s36, s36, 7340032
    buffer_store_dwordx4 v[72:75], v253, s[32:35], s36 offen sc1
    buffer_store_dwordx4 v[76:79], v253, s[32:35], s36 offen offset:1024 sc1
    s_barrier
    s_waitcnt vmcnt(13) lgkmcnt(4)
    v_mfma_f32_32x32x16_bf16 v[40:55], v[128:131], a[0:3], 0
    s_lshl_b32 s36, s65, 6
    v_xor_b32 v8, s36, v254
    v_xor_b32 v9, 64, v8
    v_add_u32 v10, 0x10000, v8
    v_mfma_f32_32x32x16_bf16 v[56:71], v[132:135], a[0:3], 0
    buffer_load_dwordx4 a[48:51], v253, s[32:35], s70 offen offset:0 sc1
    buffer_load_dwordx4 a[52:55], v253, s[32:35], s70 offen offset:1024 sc1
    buffer_load_dwordx4 a[56:59], v253, s[32:35], s70 offen offset:2048 sc1
    s_waitcnt vmcnt(15) lgkmcnt(4)
    v_mfma_f32_32x32x16_bf16 v[40:55], v[136:139], a[4:7], v[40:55]
    v_add_u32 v11, 0x10000, v9
    v_add_u32 v13, 0x20000, v8
    v_add_u32 v14, 0x20000, v9
    s_lshl_b32 s36, s65, 13
    s_lshl_b32 s37, s65, 10
    s_add_u32 s37, s37, s36
    s_xor_b32 s36, s37, 1024
    v_add_u32 v117, s37, v253
    v_add_u32 v118, s36, v253
    v_mfma_f32_32x32x16_bf16 v[56:71], v[140:143], a[4:7], v[56:71]
    buffer_load_dwordx4 a[60:63], v253, s[32:35], s70 offen offset:3072 sc1
    s_add_u32 s70, s70, 4096
    s_waitcnt vmcnt(15) lgkmcnt(4)
    v_mfma_f32_32x32x16_bf16 v[40:55], v[144:147], a[8:11], v[40:55]
    v_add_u32 v119, 0x10000, v117
    v_add_u32 v15, 0x10000, v118
    s_or_b32 s36, s2, s6
    s_cmp_eq_u32 s36, 0
    s_cselect_b32 s36, 61440, s100
    v_mov_b32 v4, s47
    v_mov_b32 v2, 0
    s_mov_b64 exec, 1
    buffer_store_dword v4, v2, s[32:35], s36 offen sc1
    s_mov_b64 exec, -1
    v_mfma_f32_32x32x16_bf16 v[56:71], v[148:151], a[8:11], v[56:71]
    buffer_load_dwordx4 a[64:67], v253, s[32:35], s70 offen offset:0 sc1
    s_waitcnt vmcnt(15) lgkmcnt(4)
    v_mfma_f32_32x32x16_bf16 v[40:55], v[152:155], a[12:15], v[40:55]
    v_mfma_f32_32x32x16_bf16 v[56:71], v[156:159], a[12:15], v[56:71]
    buffer_load_dwordx4 a[68:71], v253, s[32:35], s70 offen offset:1024 sc1
    buffer_load_dwordx4 a[72:75], v253, s[32:35], s70 offen offset:2048 sc1
    s_waitcnt vmcnt(16) lgkmcnt(4)
    v_mfma_f32_32x32x16_bf16 v[40:55], v[160:163], a[16:19], v[40:55]
    v_mfma_f32_32x32x16_bf16 v[56:71], v[164:167], a[16:19], v[56:71]
    buffer_load_dwordx4 a[76:79], v253, s[32:35], s70 offen offset:3072 sc1
    s_add_u32 s70, s70, 4096
    s_waitcnt vmcnt(16) lgkmcnt(4)
    v_mfma_f32_32x32x16_bf16 v[40:55], v[168:171], a[20:23], v[40:55]
    v_mfma_f32_32x32x16_bf16 v[56:71], v[172:175], a[20:23], v[56:71]
    buffer_load_dwordx4 a[80:83], v253, s[32:35], s70 offen offset:0 sc1
    buffer_load_dwordx4 a[84:87], v253, s[32:35], s70 offen offset:1024 sc1
    s_waitcnt vmcnt(17) lgkmcnt(4)
    s_waitcnt vmcnt(50)
    s_barrier
    v_mfma_f32_32x32x16_bf16 v[40:55], v[176:179], a[24:27], v[40:55]
    ds_read_b64_tr_b16 v[32:33], v10 offset:0
    ds_read_b64_tr_b16 v[34:35], v10 offset:1024
    v_mfma_f32_32x32x16_bf16 v[56:71], v[180:183], a[24:27], v[56:71]
    ds_read_b64_tr_b16 v[36:37], v11 offset:0
    ds_read_b64_tr_b16 v[38:39], v11 offset:1024
    buffer_load_dwordx4 a[88:91], v253, s[32:35], s70 offen offset:2048 sc1
    buffer_load_dwordx4 a[92:95], v253, s[32:35], s70 offen offset:3072 sc1
    s_add_u32 s70, s70, 4096
    s_waitcnt vmcnt(18) lgkmcnt(4)
    v_mfma_f32_32x32x16_bf16 v[40:55], v[184:187], a[28:31], v[40:55]
    ds_read_b64_tr_b16 v[16:17], v10 offset:2048
    ds_read_b64_tr_b16 v[18:19], v10 offset:3072
    v_mfma_f32_32x32x16_bf16 v[56:71], v[188:191], a[28:31], v[56:71]
    ds_read_b64_tr_b16 v[20:21], v11 offset:2048
    ds_read_b64_tr_b16 v[22:23], v11 offset:3072
    buffer_load_dwordx4 a[96:99], v253, s[32:35], s70 offen offset:0 sc1
    s_waitcnt vmcnt(18) lgkmcnt(4)
    v_mfma_f32_32x32x16_bf16 v[40:55], v[32:35], a[32:35], v[40:55]
    ds_read_b64_tr_b16 v[24:25], v10 offset:4096
    ds_read_b64_tr_b16 v[26:27], v10 offset:5120
    v_mfma_f32_32x32x16_bf16 v[56:71], v[36:39], a[32:35], v[56:71]
    ds_read_b64_tr_b16 v[28:29], v11 offset:4096
    ds_read_b64_tr_b16 v[30:31], v11 offset:5120
    buffer_load_dwordx4 a[100:103], v253, s[32:35], s70 offen offset:1024 sc1
    buffer_load_dwordx4 a[104:107], v253, s[32:35], s70 offen offset:2048 sc1
    s_waitcnt vmcnt(19) lgkmcnt(4)
    v_mfma_f32_32x32x16_bf16 v[40:55], v[16:19], a[36:39], v[40:55]
    ds_read_b64_tr_b16 v[32:33], v10 offset:6144
    ds_read_b64_tr_b16 v[34:35], v10 offset:7168
    v_mfma_f32_32x32x16_bf16 v[56:71], v[20:23], a[36:39], v[56:71]
    ds_read_b64_tr_b16 v[36:37], v11 offset:6144
    ds_read_b64_tr_b16 v[38:39], v11 offset:7168
    buffer_load_dwordx4 a[108:111], v253, s[32:35], s70 offen offset:3072 sc1
    s_add_u32 s70, s70, 4096
    s_waitcnt vmcnt(19) lgkmcnt(4)
    s_waitcnt vmcnt(52)
    s_barrier
    v_mfma_f32_32x32x16_bf16 v[40:55], v[24:27], a[40:43], v[40:55]
    ds_read_b64_tr_b16 v[16:17], v10 offset:16384
    ds_read_b64_tr_b16 v[18:19], v10 offset:17408
    v_mfma_f32_32x32x16_bf16 v[56:71], v[28:31], a[40:43], v[56:71]
    ds_read_b64_tr_b16 v[20:21], v11 offset:16384
    ds_read_b64_tr_b16 v[22:23], v11 offset:17408
    s_add_u32 m0, s45, 0
    s_add_u32 s69, s69, 16384
    buffer_load_dwordx4 v253, s[32:35], s69 offen offset:0 sc1 lds
    buffer_load_dwordx4 a[112:115], v253, s[32:35], s70 offen offset:0 sc1
    s_waitcnt vmcnt(20) lgkmcnt(4)
    v_mfma_f32_32x32x16_bf16 v[40:55], v[32:35], a[44:47], v[40:55]
    ds_read_b64_tr_b16 v[24:25], v10 offset:18432
    ds_read_b64_tr_b16 v[26:27], v10 offset:19456
    v_mfma_f32_32x32x16_bf16 v[56:71], v[36:39], a[44:47], v[56:71]
    ds_read_b64_tr_b16 v[28:29], v11 offset:18432
    ds_read_b64_tr_b16 v[30:31], v11 offset:19456
    buffer_load_dwordx4 v253, s[32:35], s69 offen offset:1024 sc1 lds
    buffer_load_dwordx4 a[116:119], v253, s[32:35], s70 offen offset:1024 sc1
    s_waitcnt vmcnt(19) lgkmcnt(4)
    v_mfma_f32_32x32x16_bf16 v[40:55], v[16:19], a[48:51], v[40:55]
    ds_read_b64_tr_b16 v[32:33], v10 offset:20480
    ds_read_b64_tr_b16 v[34:35], v10 offset:21504
    v_mfma_f32_32x32x16_bf16 v[56:71], v[20:23], a[48:51], v[56:71]
    ds_read_b64_tr_b16 v[36:37], v11 offset:20480
    ds_read_b64_tr_b16 v[38:39], v11 offset:21504
    s_waitcnt vmcnt(20)
    s_add_u32 s36, s101, 17840128
    v_mov_b32 v3, s47
    v_mov_b32 v2, 0
    s_mov_b64 exec, 1
    buffer_store_dword v3, v2, s[32:35], s36 offen sc1
    s_mov_b64 exec, -1
    buffer_load_dwordx4 v253, s[32:35], s69 offen offset:2048 sc1 lds
    s_waitcnt vmcnt(19) lgkmcnt(4)
    v_mfma_f32_32x32x16_bf16 v[40:55], v[24:27], a[52:55], v[40:55]
    ds_read_b64_tr_b16 v[16:17], v10 offset:22528
    ds_read_b64_tr_b16 v[18:19], v10 offset:23552
    v_mfma_f32_32x32x16_bf16 v[56:71], v[28:31], a[52:55], v[56:71]
    ds_read_b64_tr_b16 v[20:21], v11 offset:22528
    ds_read_b64_tr_b16 v[22:23], v11 offset:23552
    buffer_load_dwordx4 a[120:123], v253, s[32:35], s70 offen offset:2048 sc1
    buffer_load_dwordx4 v253, s[32:35], s69 offen offset:3072 sc1 lds
    s_waitcnt vmcnt(20) lgkmcnt(4)
    s_waitcnt vmcnt(55)
    s_barrier
    v_mfma_f32_32x32x16_bf16 v[40:55], v[32:35], a[56:59], v[40:55]
    ds_read_b64_tr_b16 v[24:25], v10 offset:32768
    ds_read_b64_tr_b16 v[26:27], v10 offset:33792
    v_mfma_f32_32x32x16_bf16 v[56:71], v[36:39], a[56:59], v[56:71]
    ds_read_b64_tr_b16 v[28:29], v11 offset:32768
    ds_read_b64_tr_b16 v[30:31], v11 offset:33792
    buffer_load_dwordx4 a[124:127], v253, s[32:35], s70 offen offset:3072 sc1
    s_add_u32 s70, s70, 4096
    s_waitcnt vmcnt(20) lgkmcnt(4)
    v_mfma_f32_32x32x16_bf16 v[40:55], v[16:19], a[60:63], v[40:55]
    ds_read_b64_tr_b16 v[32:33], v10 offset:34816
    ds_read_b64_tr_b16 v[34:35], v10 offset:35840
    v_mfma_f32_32x32x16_bf16 v[56:71], v[20:23], a[60:63], v[56:71]
    ds_read_b64_tr_b16 v[36:37], v11 offset:34816
    ds_read_b64_tr_b16 v[38:39], v11 offset:35840
    s_add_u32 m0, s45, 16384
    s_add_u32 s69, s69, 16384
    buffer_load_dwordx4 v253, s[32:35], s69 offen offset:0 sc1 lds
    buffer_load_dwordx4 a[128:131], v253, s[32:35], s70 offen offset:0 sc1
    s_waitcnt vmcnt(21) lgkmcnt(4)
    v_mfma_f32_32x32x16_bf16 v[40:55], v[24:27], a[64:67], v[40:55]
    ds_read_b64_tr_b16 v[16:17], v10 offset:36864
    ds_read_b64_tr_b16 v[18:19], v10 offset:37888
    v_mfma_f32_32x32x16_bf16 v[56:71], v[28:31], a[64:67], v[56:71]
    ds_read_b64_tr_b16 v[20:21], v11 offset:36864
    ds_read_b64_tr_b16 v[22:23], v11 offset:37888
    buffer_load_dwordx4 v253, s[32:35], s69 offen offset:1024 sc1 lds
    buffer_load_dwordx4 a[132:135], v253, s[32:35], s70 offen offset:1024 sc1
    s_waitcnt vmcnt(22) lgkmcnt(4)
    v_mfma_f32_32x32x16_bf16 v[40:55], v[32:35], a[68:71], v[40:55]
    ds_read_b64_tr_b16 v[24:25], v10 offset:38912
    ds_read_b64_tr_b16 v[26:27], v10 offset:39936
    v_mfma_f32_32x32x16_bf16 v[56:71], v[36:39], a[68:71], v[56:71]
    ds_read_b64_tr_b16 v[28:29], v11 offset:38912
    ds_read_b64_tr_b16 v[30:31], v11 offset:39936
    buffer_load_dwordx4 v253, s[32:35], s69 offen offset:2048 sc1 lds
    s_waitcnt vmcnt(22) lgkmcnt(4)
    s_waitcnt vmcnt(57)
    s_barrier
    v_mfma_f32_32x32x16_bf16 v[40:55], v[16:19], a[72:75], v[40:55]
    ds_read_b64_tr_b16 v[32:33], v10 offset:49152
    ds_read_b64_tr_b16 v[34:35], v10 offset:50176
    v_mfma_f32_32x32x16_bf16 v[56:71], v[20:23], a[72:75], v[56:71]
    ds_read_b64_tr_b16 v[36:37], v11 offset:49152
    ds_read_b64_tr_b16 v[38:39], v11 offset:50176
    buffer_load_dwordx4 a[136:139], v253, s[32:35], s70 offen offset:2048 sc1
    buffer_load_dwordx4 v253, s[32:35], s69 offen offset:3072 sc1 lds
    s_waitcnt vmcnt(23) lgkmcnt(4)
    v_mfma_f32_32x32x16_bf16 v[40:55], v[24:27], a[76:79], v[40:55]
    ds_read_b64_tr_b16 v[16:17], v10 offset:51200
    ds_read_b64_tr_b16 v[18:19], v10 offset:52224
    v_mfma_f32_32x32x16_bf16 v[56:71], v[28:31], a[76:79], v[56:71]
    ds_read_b64_tr_b16 v[20:21], v11 offset:51200
    ds_read_b64_tr_b16 v[22:23], v11 offset:52224
    buffer_load_dwordx4 a[140:143], v253, s[32:35], s70 offen offset:3072 sc1
    s_add_u32 s70, s70, 4096
    s_waitcnt vmcnt(23) lgkmcnt(4)
    v_mfma_f32_32x32x16_bf16 v[40:55], v[32:35], a[80:83], v[40:55]
    ds_read_b64_tr_b16 v[24:25], v10 offset:53248
    ds_read_b64_tr_b16 v[26:27], v10 offset:54272
    v_mfma_f32_32x32x16_bf16 v[56:71], v[36:39], a[80:83], v[56:71]
    ds_read_b64_tr_b16 v[28:29], v11 offset:53248
    ds_read_b64_tr_b16 v[30:31], v11 offset:54272
    s_add_u32 m0, s45, 32768
    s_add_u32 s69, s69, 16384
    buffer_load_dwordx4 v253, s[32:35], s69 offen offset:0 sc1 lds
    buffer_load_dwordx4 a[144:147], v253, s[32:35], s70 offen offset:0 sc1
    s_waitcnt vmcnt(24) lgkmcnt(4)
    v_mfma_f32_32x32x16_bf16 v[40:55], v[16:19], a[84:87], v[40:55]
    ds_read_b64_tr_b16 v[32:33], v10 offset:55296
    ds_read_b64_tr_b16 v[34:35], v10 offset:56320
    v_mfma_f32_32x32x16_bf16 v[56:71], v[20:23], a[84:87], v[56:71]
    ds_read_b64_tr_b16 v[36:37], v11 offset:55296
    ds_read_b64_tr_b16 v[38:39], v11 offset:56320
    buffer_load_dwordx4 v253, s[32:35], s69 offen offset:1024 sc1 lds
    buffer_load_dwordx4 a[148:151], v253, s[32:35], s70 offen offset:1024 sc1
    s_waitcnt vmcnt(25) lgkmcnt(4)
    s_waitcnt vmcnt(54)
    s_barrier
    v_mfma_f32_32x32x16_bf16 v[40:55], v[24:27], a[88:91], v[40:55]
    ds_read_b64_tr_b16 v[16:17], v8 offset:49152
    ds_read_b64_tr_b16 v[18:19], v8 offset:50176
    v_mfma_f32_32x32x16_bf16 v[56:71], v[28:31], a[88:91], v[56:71]
    ds_read_b64_tr_b16 v[20:21], v9 offset:49152
    ds_read_b64_tr_b16 v[22:23], v9 offset:50176
    buffer_load_dwordx4 v253, s[32:35], s69 offen offset:2048 sc1 lds
    s_waitcnt vmcnt(25) lgkmcnt(4)
    v_mfma_f32_32x32x16_bf16 v[40:55], v[32:35], a[92:95], v[40:55]
    ds_read_b64_tr_b16 v[24:25], v8 offset:51200
    ds_read_b64_tr_b16 v[26:27], v8 offset:52224
    v_mfma_f32_32x32x16_bf16 v[56:71], v[36:39], a[92:95], v[56:71]
    ds_read_b64_tr_b16 v[28:29], v9 offset:51200
    ds_read_b64_tr_b16 v[30:31], v9 offset:52224
    buffer_load_dwordx4 a[152:155], v253, s[32:35], s70 offen offset:2048 sc1
    buffer_load_dwordx4 v253, s[32:35], s69 offen offset:3072 sc1 lds
    s_waitcnt vmcnt(26) lgkmcnt(4)
    v_mfma_f32_32x32x16_bf16 v[40:55], v[16:19], a[96:99], v[40:55]
    ds_read_b64_tr_b16 v[32:33], v8 offset:53248
    ds_read_b64_tr_b16 v[34:35], v8 offset:54272
    v_mfma_f32_32x32x16_bf16 v[56:71], v[20:23], a[96:99], v[56:71]
    ds_read_b64_tr_b16 v[36:37], v9 offset:53248
    ds_read_b64_tr_b16 v[38:39], v9 offset:54272
    buffer_load_dwordx4 a[156:159], v253, s[32:35], s70 offen offset:3072 sc1
    s_add_u32 s70, s70, 4096
    s_waitcnt vmcnt(26) lgkmcnt(4)
    v_mfma_f32_32x32x16_bf16 v[40:55], v[24:27], a[100:103], v[40:55]
    ds_read_b64_tr_b16 v[16:17], v8 offset:55296
    ds_read_b64_tr_b16 v[18:19], v8 offset:56320
    v_mfma_f32_32x32x16_bf16 v[56:71], v[28:31], a[100:103], v[56:71]
    ds_read_b64_tr_b16 v[20:21], v9 offset:55296
    ds_read_b64_tr_b16 v[22:23], v9 offset:56320
    s_add_u32 m0, s45, 65536
    s_add_u32 s69, s69, 16384
    buffer_load_dwordx4 v253, s[32:35], s69 offen offset:0 sc1 lds
    buffer_load_dwordx4 a[160:163], v253, s[32:35], s70 offen offset:0 sc1
    s_waitcnt vmcnt(27) lgkmcnt(4)
    s_waitcnt vmcnt(56)
    s_barrier
    v_mfma_f32_32x32x16_bf16 v[40:55], v[32:35], a[104:107], v[40:55]
    ds_read_b64_tr_b16 v[24:25], v13 offset:0
    ds_read_b64_tr_b16 v[26:27], v13 offset:1024
    v_mfma_f32_32x32x16_bf16 v[56:71], v[36:39], a[104:107], v[56:71]
    ds_read_b64_tr_b16 v[28:29], v14 offset:0
    ds_read_b64_tr_b16 v[30:31], v14 offset:1024
    buffer_load_dwordx4 v253, s[32:35], s69 offen offset:1024 sc1 lds
    buffer_load_dwordx4 a[164:167], v253, s[32:35], s70 offen offset:1024 sc1
    s_waitcnt vmcnt(28) lgkmcnt(4)
    v_mfma_f32_32x32x16_bf16 v[40:55], v[16:19], a[108:111], v[40:55]
    ds_read_b64_tr_b16 v[32:33], v13 offset:2048
    ds_read_b64_tr_b16 v[34:35], v13 offset:3072
    v_mfma_f32_32x32x16_bf16 v[56:71], v[20:23], a[108:111], v[56:71]
    ds_read_b64_tr_b16 v[36:37], v14 offset:2048
    ds_read_b64_tr_b16 v[38:39], v14 offset:3072
    buffer_load_dwordx4 v253, s[32:35], s69 offen offset:2048 sc1 lds
    s_waitcnt vmcnt(27) lgkmcnt(4)
    v_mfma_f32_32x32x16_bf16 v[40:55], v[24:27], a[112:115], v[40:55]
    ds_read_b64_tr_b16 v[16:17], v13 offset:4096
    ds_read_b64_tr_b16 v[18:19], v13 offset:5120
    v_mfma_f32_32x32x16_bf16 v[56:71], v[28:31], a[112:115], v[56:71]
    ds_read_b64_tr_b16 v[20:21], v14 offset:4096
    ds_read_b64_tr_b16 v[22:23], v14 offset:5120
    buffer_load_dwordx4 a[168:171], v253, s[32:35], s70 offen offset:2048 sc1
    buffer_load_dwordx4 v253, s[32:35], s69 offen offset:3072 sc1 lds
    s_waitcnt vmcnt(27) lgkmcnt(4)
    v_mfma_f32_32x32x16_bf16 v[40:55], v[32:35], a[116:119], v[40:55]
    ds_read_b64_tr_b16 v[24:25], v13 offset:6144
    ds_read_b64_tr_b16 v[26:27], v13 offset:7168
    v_mfma_f32_32x32x16_bf16 v[56:71], v[36:39], a[116:119], v[56:71]
    ds_read_b64_tr_b16 v[28:29], v14 offset:6144
    ds_read_b64_tr_b16 v[30:31], v14 offset:7168
    buffer_load_dwordx4 a[172:175], v253, s[32:35], s70 offen offset:3072 sc1
    s_add_u32 s70, s70, 4096
    s_add_u32 m0, s45, 81920
    s_add_u32 s69, s69, 16384
    buffer_load_dwordx4 v253, s[32:35], s69 offen offset:0 sc1 lds
    s_waitcnt vmcnt(27) lgkmcnt(4)
    s_waitcnt vmcnt(26)
    s_barrier
    v_mfma_f32_32x32x16_bf16 v[40:55], v[16:19], a[120:123], v[40:55]
    ds_read_b128 v[32:35], v117 offset:0
    ds_read_b128 v[36:39], v118 offset:0
    v_mfma_f32_32x32x16_bf16 v[56:71], v[20:23], a[120:123], v[56:71]
    buffer_load_dwordx4 a[176:179], v253, s[32:35], s70 offen offset:0 sc1
    buffer_load_dwordx4 v253, s[32:35], s69 offen offset:1024 sc1 lds
    s_waitcnt vmcnt(27) lgkmcnt(2)
    v_mfma_f32_32x32x16_bf16 v[40:55], v[24:27], a[124:127], v[40:55]
    ds_read_b128 v[16:19], v117 offset:2048
    ds_read_b128 v[20:23], v118 offset:2048
    v_mfma_f32_32x32x16_bf16 v[56:71], v[28:31], a[124:127], v[56:71]
    buffer_load_dwordx4 a[180:183], v253, s[32:35], s70 offen offset:1024 sc1
    buffer_load_dwordx4 v253, s[32:35], s69 offen offset:2048 sc1 lds
    s_waitcnt vmcnt(27) lgkmcnt(2)
    v_mfma_f32_32x32x16_bf16 v[40:55], v[32:35], a[128:131], v[40:55]
    ds_read_b128 v[24:27], v117 offset:4096
    ds_read_b128 v[28:31], v118 offset:4096
    v_mfma_f32_32x32x16_bf16 v[56:71], v[36:39], a[128:131], v[56:71]
    buffer_load_dwordx4 a[184:187], v253, s[32:35], s70 offen offset:2048 sc1
    buffer_load_dwordx4 v253, s[32:35], s69 offen offset:3072 sc1 lds
    s_waitcnt vmcnt(27) lgkmcnt(2)
    v_mfma_f32_32x32x16_bf16 v[40:55], v[16:19], a[132:135], v[40:55]
    ds_read_b128 v[32:35], v117 offset:6144
    ds_read_b128 v[36:39], v118 offset:6144
    v_mfma_f32_32x32x16_bf16 v[56:71], v[20:23], a[132:135], v[56:71]
    buffer_load_dwordx4 a[188:191], v253, s[32:35], s70 offen offset:3072 sc1
    s_add_u32 s70, s70, 4096
    s_add_u32 m0, s45, 98304
    s_add_u32 s69, s69, 16384
    buffer_load_dwordx4 v253, s[32:35], s69 offen offset:0 sc1 lds
    s_waitcnt vmcnt(27) lgkmcnt(2)
    s_waitcnt vmcnt(26)
    s_barrier
    v_mfma_f32_32x32x16_bf16 v[40:55], v[24:27], a[136:139], v[40:55]
    ds_read_b128 v[16:19], v117 offset:16384
    ds_read_b128 v[20:23], v118 offset:16384
    v_mfma_f32_32x32x16_bf16 v[56:71], v[28:31], a[136:139], v[56:71]
    s_lshl_b32 s36, s98, 8
    s_add_u32 s36, s36, 17840128
    v_lshlrev_b32 v2, 2, v1
    buffer_load_dword v124, v2, s[32:35], s36 offen sc1
    buffer_load_dwordx4 a[192:195], v253, s[32:35], s70 offen offset:0 sc1
    buffer_load_dwordx4 v253, s[32:35], s69 offen offset:1024 sc1 lds
    s_waitcnt vmcnt(28) lgkmcnt(2)
    v_mfma_f32_32x32x16_bf16 v[40:55], v[32:35], a[140:143], v[40:55]
    ds_read_b128 v[24:27], v117 offset:18432
    ds_read_b128 v[28:31], v118 offset:18432
    v_mfma_f32_32x32x16_bf16 v[56:71], v[36:39], a[140:143], v[56:71]
    buffer_load_dwordx4 a[196:199], v253, s[32:35], s70 offen offset:1024 sc1
    buffer_load_dwordx4 v253, s[32:35], s69 offen offset:2048 sc1 lds
    s_waitcnt vmcnt(28) lgkmcnt(2)
    v_mfma_f32_32x32x16_bf16 v[40:55], v[16:19], a[144:147], v[40:55]
    ds_read_b128 v[32:35], v117 offset:20480
    ds_read_b128 v[36:39], v118 offset:20480
    v_mfma_f32_32x32x16_bf16 v[56:71], v[20:23], a[144:147], v[56:71]
    buffer_load_dwordx4 a[200:203], v253, s[32:35], s70 offen offset:2048 sc1
    buffer_load_dwordx4 v253, s[32:35], s69 offen offset:3072 sc1 lds
    s_waitcnt vmcnt(28) lgkmcnt(2)
    v_mfma_f32_32x32x16_bf16 v[40:55], v[24:27], a[148:151], v[40:55]
    ds_read_b128 v[16:19], v117 offset:22528
    ds_read_b128 v[20:23], v118 offset:22528
    v_mfma_f32_32x32x16_bf16 v[56:71], v[28:31], a[148:151], v[56:71]
    buffer_load_dwordx4 a[204:207], v253, s[32:35], s70 offen offset:3072 sc1
    s_add_u32 s70, s70, 4096
    s_add_u32 m0, s45, 114688
    s_add_u32 s69, s69, 16384
    buffer_load_dwordx4 v253, s[32:35], s69 offen offset:0 sc1 lds
    s_waitcnt vmcnt(28) lgkmcnt(2)
    s_waitcnt vmcnt(27)
    s_barrier
    v_mfma_f32_32x32x16_bf16 v[40:55], v[32:35], a[152:155], v[40:55]
    ds_read_b128 v[24:27], v117 offset:32768
    ds_read_b128 v[28:31], v118 offset:32768
    v_mfma_f32_32x32x16_bf16 v[56:71], v[36:39], a[152:155], v[56:71]
    buffer_load_dwordx4 a[208:211], v253, s[32:35], s70 offen offset:0 sc1
    buffer_load_dwordx4 v253, s[32:35], s69 offen offset:1024 sc1 lds
    s_waitcnt vmcnt(28) lgkmcnt(2)
    v_mfma_f32_32x32x16_bf16 v[40:55], v[16:19], a[156:159], v[40:55]
    ds_read_b128 v[32:35], v117 offset:34816
    ds_read_b128 v[36:39], v118 offset:34816
    v_mfma_f32_32x32x16_bf16 v[56:71], v[20:23], a[156:159], v[56:71]
    buffer_load_dwordx4 a[212:215], v253, s[32:35], s70 offen offset:1024 sc1
    buffer_load_dwordx4 v253, s[32:35], s69 offen offset:2048 sc1 lds
    s_waitcnt vmcnt(28) lgkmcnt(2)
    v_mfma_f32_32x32x16_bf16 v[40:55], v[24:27], a[160:163], v[40:55]
    ds_read_b128 v[16:19], v117 offset:36864
    ds_read_b128 v[20:23], v118 offset:36864
    v_mfma_f32_32x32x16_bf16 v[56:71], v[28:31], a[160:163], v[56:71]
    s_waitcnt vmcnt(12)
    v_cmp_eq_u32 vcc, s47, v124
    s_nop 0
    s_cmp_eq_u64 vcc, -1
    s_cbranch_scc0 L_ap_spin
L_ap_ok:
    buffer_load_dwordx4 a[224:227], v253, s[32:35], s71 offen offset:0 sc1
    buffer_load_dwordx4 a[228:231], v253, s[32:35], s71 offen offset:1024 sc1
    buffer_load_dwordx4 a[232:235], v253, s[32:35], s71 offen offset:2048 sc1
    buffer_load_dwordx4 a[236:239], v253, s[32:35], s71 offen offset:3072 sc1
    s_add_u32 s71, s71, 4096
    buffer_load_dwordx4 a[240:243], v253, s[32:35], s71 offen offset:0 sc1
    buffer_load_dwordx4 a[244:247], v253, s[32:35], s71 offen offset:1024 sc1
    buffer_load_dwordx4 a[216:219], v253, s[32:35], s70 offen offset:2048 sc1
    buffer_load_dwordx4 v253, s[32:35], s69 offen offset:3072 sc1 lds
    buffer_load_dwordx4 a[248:251], v253, s[32:35], s71 offen offset:2048 sc1
    s_waitcnt vmcnt(35) lgkmcnt(2)
    v_mfma_f32_32x32x16_bf16 v[40:55], v[32:35], a[164:167], v[40:55]
    ds_read_b128 v[24:27], v117 offset:38912
    ds_read_b128 v[28:31], v118 offset:38912
    v_mfma_f32_32x32x16_bf16 v[56:71], v[36:39], a[164:167], v[56:71]
    buffer_load_dwordx4 a[220:223], v253, s[32:35], s70 offen offset:3072 sc1
    s_add_u32 s70, s70, 4096
    s_add_u32 m0, s45, 0
    s_add_u32 s69, s69, 16384
    buffer_load_dwordx4 v253, s[32:35], s69 offen offset:0 sc1 lds
    buffer_load_dwordx4 a[252:255], v253, s[32:35], s71 offen offset:3072 sc1
    s_add_u32 s71, s71, 4096
    s_waitcnt vmcnt(36) lgkmcnt(2)
    s_waitcnt vmcnt(35)
    s_barrier
    v_mfma_f32_32x32x16_bf16 v[40:55], v[16:19], a[168:171], v[40:55]
    ds_read_b128 v[32:35], v119 offset:0
    ds_read_b128 v[36:39], v15 offset:0
    v_mfma_f32_32x32x16_bf16 v[56:71], v[20:23], a[168:171], v[56:71]
    buffer_load_dwordx4 v253, s[32:35], s69 offen offset:1024 sc1 lds
    buffer_load_dwordx4 a[0:3], v253, s[32:35], s71 offen offset:0 sc1
    s_waitcnt vmcnt(36) lgkmcnt(2)
    v_mfma_f32_32x32x16_bf16 v[40:55], v[24:27], a[172:175], v[40:55]
    ds_read_b128 v[16:19], v119 offset:2048
    ds_read_b128 v[20:23], v15 offset:2048
    v_mfma_f32_32x32x16_bf16 v[56:71], v[28:31], a[172:175], v[56:71]
    buffer_load_dwordx4 v253, s[32:35], s69 offen offset:2048 sc1 lds
    buffer_load_dwordx4 a[4:7], v253, s[32:35], s71 offen offset:1024 sc1
    s_waitcnt vmcnt(36) lgkmcnt(2)
    v_mfma_f32_32x32x16_bf16 v[40:55], v[32:35], a[176:179], v[40:55]
    ds_read_b128 v[24:27], v119 offset:4096
    ds_read_b128 v[28:31], v15 offset:4096
    v_mfma_f32_32x32x16_bf16 v[56:71], v[36:39], a[176:179], v[56:71]
    buffer_load_dwordx4 v253, s[32:35], s69 offen offset:3072 sc1 lds
    buffer_load_dwordx4 a[8:11], v253, s[32:35], s71 offen offset:2048 sc1
    s_waitcnt vmcnt(36) lgkmcnt(2)
    v_mfma_f32_32x32x16_bf16 v[40:55], v[16:19], a[180:183], v[40:55]
    ds_read_b128 v[32:35], v119 offset:6144
    ds_read_b128 v[36:39], v15 offset:6144
    v_mfma_f32_32x32x16_bf16 v[56:71], v[20:23], a[180:183], v[56:71]
    s_add_u32 m0, s45, 16384
    s_add_u32 s69, s69, 16384
    buffer_load_dwordx4 v253, s[32:35], s69 offen offset:0 sc1 lds
    buffer_load_dwordx4 a[12:15], v253, s[32:35], s71 offen offset:3072 sc1
    s_add_u32 s71, s71, 4096
    s_waitcnt vmcnt(36) lgkmcnt(2)
    s_waitcnt vmcnt(35)
    s_barrier
    v_mfma_f32_32x32x16_bf16 v[40:55], v[24:27], a[184:187], v[40:55]
    ds_read_b128 v[16:19], v119 offset:16384
    ds_read_b128 v[20:23], v15 offset:16384
    v_mfma_f32_32x32x16_bf16 v[56:71], v[28:31], a[184:187], v[56:71]
    buffer_load_dwordx4 v253, s[32:35], s69 offen offset:1024 sc1 lds
    buffer_load_dwordx4 a[16:19], v253, s[32:35], s71 offen offset:0 sc1
    s_waitcnt vmcnt(36) lgkmcnt(2)
    v_mfma_f32_32x32x16_bf16 v[40:55], v[32:35], a[188:191], v[40:55]
    ds_read_b128 v[24:27], v119 offset:18432
    ds_read_b128 v[28:31], v15 offset:18432
    v_mfma_f32_32x32x16_bf16 v[56:71], v[36:39], a[188:191], v[56:71]
    buffer_load_dwordx4 v253, s[32:35], s69 offen offset:2048 sc1 lds
    buffer_load_dwordx4 a[20:23], v253, s[32:35], s71 offen offset:1024 sc1
    s_waitcnt vmcnt(35) lgkmcnt(2)
    v_mfma_f32_32x32x16_bf16 v[40:55], v[16:19], a[192:195], v[40:55]
    ds_read_b128 v[32:35], v119 offset:20480
    ds_read_b128 v[36:39], v15 offset:20480
    v_mfma_f32_32x32x16_bf16 v[56:71], v[20:23], a[192:195], v[56:71]
    buffer_load_dwordx4 v253, s[32:35], s69 offen offset:3072 sc1 lds
    buffer_load_dwordx4 a[24:27], v253, s[32:35], s71 offen offset:2048 sc1
    s_waitcnt vmcnt(35) lgkmcnt(2)
    v_mfma_f32_32x32x16_bf16 v[40:55], v[24:27], a[196:199], v[40:55]
    ds_read_b128 v[16:19], v119 offset:22528
    ds_read_b128 v[20:23], v15 offset:22528
    v_mfma_f32_32x32x16_bf16 v[56:71], v[28:31], a[196:199], v[56:71]
    s_add_u32 m0, s45, 32768
    s_add_u32 s69, s69, 16384
    buffer_load_dwordx4 v253, s[32:35], s69 offen offset:0 sc1 lds
    buffer_load_dwordx4 a[28:31], v253, s[32:35], s71 offen offset:3072 sc1
    s_add_u32 s71, s71, 4096
    s_waitcnt vmcnt(35) lgkmcnt(2)
    s_waitcnt vmcnt(34)
    s_barrier
    v_mfma_f32_32x32x16_bf16 v[40:55], v[32:35], a[200:203], v[40:55]
    ds_read_b128 v[24:27], v119 offset:32768
    ds_read_b128 v[28:31], v15 offset:32768
    v_mfma_f32_32x32x16_bf16 v[56:71], v[36:39], a[200:203], v[56:71]
    buffer_load_dwordx4 v253, s[32:35], s69 offen offset:1024 sc1 lds
    s_waitcnt vmcnt(34) lgkmcnt(2)
    v_mfma_f32_32x32x16_bf16 v[40:55], v[16:19], a[204:207], v[40:55]
    ds_read_b128 v[32:35], v119 offset:34816
    ds_read_b128 v[36:39], v15 offset:34816
    v_mfma_f32_32x32x16_bf16 v[56:71], v[20:23], a[204:207], v[56:71]
    buffer_load_dwordx4 v253, s[32:35], s69 offen offset:2048 sc1 lds
    s_waitcnt vmcnt(33) lgkmcnt(2)
    v_mfma_f32_32x32x16_bf16 v[40:55], v[24:27], a[208:211], v[40:55]
    ds_read_b128 v[16:19], v119 offset:36864
    ds_read_b128 v[20:23], v15 offset:36864
    v_mfma_f32_32x32x16_bf16 v[56:71], v[28:31], a[208:211], v[56:71]
    buffer_load_dwordx4 v253, s[32:35], s69 offen offset:3072 sc1 lds
    s_waitcnt vmcnt(32) lgkmcnt(2)
    v_mfma_f32_32x32x16_bf16 v[40:55], v[32:35], a[212:215], v[40:55]
    ds_read_b128 v[24:27], v119 offset:38912
    ds_read_b128 v[28:31], v15 offset:38912
    v_mfma_f32_32x32x16_bf16 v[56:71], v[36:39], a[212:215], v[56:71]
    s_waitcnt vmcnt(24) lgkmcnt(2)
    s_waitcnt vmcnt(23)
    s_barrier
    v_mfma_f32_32x32x16_bf16 v[40:55], v[16:19], a[216:219], v[40:55]
    ds_read_b128 v[32:35], v119 offset:49152
    ds_read_b128 v[36:39], v15 offset:49152
    v_mfma_f32_32x32x16_bf16 v[56:71], v[20:23], a[216:219], v[56:71]
    s_waitcnt vmcnt(21) lgkmcnt(2)
    v_mfma_f32_32x32x16_bf16 v[40:55], v[24:27], a[220:223], v[40:55]
    ds_read_b128 v[16:19], v119 offset:51200
    ds_read_b128 v[20:23], v15 offset:51200
    v_mfma_f32_32x32x16_bf16 v[56:71], v[28:31], a[220:223], v[56:71]
    s_waitcnt vmcnt(30) lgkmcnt(2)
    v_mfma_f32_32x32x16_bf16 v[72:87], v[32:35], a[224:227], 0
    ds_read_b128 v[24:27], v119 offset:53248
    ds_read_b128 v[28:31], v15 offset:53248
    v_mfma_f32_32x32x16_bf16 v[88:103], v[36:39], a[224:227], 0
    s_lshl_b32 s36, s64, 1
    s_add_u32 s37, s36, s65
    s_lshl_b32 s37, s37, 12
    s_xor_b32 s36, s37, 4096
    v_lshlrev_b32 v2, 4, v1
    v_add_u32 v114, s37, v2
    v_add_u32 v115, s36, v2
    v_and_b32 v2, 31, v1
    s_lshl_b32 s36, s66, 5
    v_add_u32 v2, s36, v2
    v_lshlrev_b32 v2, 10, v2
    v_lshrrev_b32 v3, 5, v1
    v_lshl_add_u32 v116, v3, 4, v2
    s_waitcnt vmcnt(29) lgkmcnt(2)
    v_mfma_f32_32x32x16_bf16 v[72:87], v[16:19], a[228:231], v[72:87]
    ds_write_b128 v114, v[56:59] offset:49152
    ds_write_b128 v114, v[60:63] offset:50176
    ds_write_b128 v114, v[64:67] offset:51200
    ds_write_b128 v114, v[68:71] offset:52224
    ds_read_b128 v[32:35], v119 offset:55296
    ds_read_b128 v[36:39], v15 offset:55296
    v_mfma_f32_32x32x16_bf16 v[88:103], v[20:23], a[228:231], v[88:103]
    s_waitcnt vmcnt(28) lgkmcnt(2)
    s_waitcnt vmcnt(14)
    s_barrier
    v_mfma_f32_32x32x16_bf16 v[72:87], v[24:27], a[232:235], v[72:87]
    ds_read_b128 v[120:123], v115 offset:49152
    ds_read_b128 v[124:127], v115 offset:50176
    ds_read_b128 v[128:131], v115 offset:51200
    ds_read_b128 v[132:135], v115 offset:52224
    ds_read_b128 v[16:19], v117 offset:0
    ds_read_b128 v[20:23], v118 offset:0
    v_mfma_f32_32x32x16_bf16 v[88:103], v[28:31], a[232:235], v[88:103]
    s_waitcnt vmcnt(27) lgkmcnt(2)
    v_mfma_f32_32x32x16_bf16 v[72:87], v[32:35], a[236:239], v[72:87]
    ds_read_b128 v[24:27], v117 offset:2048
    ds_read_b128 v[28:31], v118 offset:2048
    v_mfma_f32_32x32x16_bf16 v[88:103], v[36:39], a[236:239], v[88:103]
    v_add_u32 v6, 131072, v114
    v_add_u32 v7, 131072, v115
    s_waitcnt vmcnt(26) lgkmcnt(2)
    v_mfma_f32_32x32x16_bf16 v[72:87], v[16:19], a[240:243], v[72:87]
    ds_read_b128 v[32:35], v117 offset:4096
    ds_read_b128 v[36:39], v118 offset:4096
    s_waitcnt vmcnt(63)
    v_cmp_eq_u32 vcc, s47, v238
    s_nop 0
    s_cmp_eq_u64 vcc, -1
    s_cbranch_scc0 L_st_spin
L_st_ok:
    v_mul_f32 v13, 0xbfb8aa3b, v237
    v_add_f32 v40, v40, v120
    v_mfma_f32_32x32x16_bf16 v[88:103], v[20:23], a[240:243], v[88:103]
    v_add_f32 v41, v41, v121
    v_add_f32 v42, v42, v122
    v_add_f32 v43, v43, v123
    v_add_f32 v44, v44, v124
    v_add_f32 v45, v45, v125
    s_waitcnt vmcnt(25) lgkmcnt(2)
    v_mfma_f32_32x32x16_bf16 v[72:87], v[24:27], a[244:247], v[72:87]
    ds_read_b128 v[16:19], v117 offset:6144
    ds_read_b128 v[20:23], v118 offset:6144
    v_add_f32 v46, v46, v126
    v_add_f32 v47, v47, v127
    v_add_f32 v48, v48, v128
    v_add_f32 v49, v49, v129
    v_add_f32 v50, v50, v130
    v_mfma_f32_32x32x16_bf16 v[88:103], v[28:31], a[244:247], v[88:103]
    v_add_f32 v51, v51, v131
    v_add_f32 v52, v52, v132
    v_add_f32 v53, v53, v133
    v_add_f32 v54, v54, v134
    v_add_f32 v55, v55, v135
    s_waitcnt vmcnt(22) lgkmcnt(2)
    s_waitcnt vmcnt(6)
    s_barrier
    v_mfma_f32_32x32x16_bf16 v[72:87], v[32:35], a[248:251], v[72:87]
    ds_read_b128 v[24:27], v117 offset:16384
    ds_read_b128 v[28:31], v118 offset:16384
    v_mul_f32 v120, v40, v13
    v_mul_f32 v121, v41, v13
    v_mul_f32 v122, v42, v13
    v_mul_f32 v123, v43, v13
    v_mul_f32 v124, v44, v13
    v_mfma_f32_32x32x16_bf16 v[88:103], v[36:39], a[248:251], v[88:103]
    v_mul_f32 v125, v45, v13
    v_mul_f32 v126, v46, v13
    v_mul_f32 v127, v47, v13
    v_mul_f32 v128, v48, v13
    v_mul_f32 v129, v49, v13
    s_waitcnt vmcnt(19) lgkmcnt(2)
    v_mfma_f32_32x32x16_bf16 v[72:87], v[16:19], a[252:255], v[72:87]
    ds_read_b128 v[32:35], v117 offset:18432
    ds_read_b128 v[36:39], v118 offset:18432
    v_mul_f32 v130, v50, v13
    v_mul_f32 v131, v51, v13
    v_mul_f32 v132, v52, v13
    v_mul_f32 v133, v53, v13
    v_mul_f32 v134, v54, v13
    v_mfma_f32_32x32x16_bf16 v[88:103], v[20:23], a[252:255], v[88:103]
    v_mul_f32 v135, v55, v13
    v_exp_f32 v120, v120
    v_exp_f32 v121, v121
    s_waitcnt vmcnt(17) lgkmcnt(2)
    v_mfma_f32_32x32x16_bf16 v[72:87], v[24:27], a[0:3], v[72:87]
    ds_read_b128 v[16:19], v117 offset:20480
    ds_read_b128 v[20:23], v118 offset:20480
    v_exp_f32 v122, v122
    v_exp_f32 v123, v123
    v_exp_f32 v124, v124
    v_mfma_f32_32x32x16_bf16 v[88:103], v[28:31], a[0:3], v[88:103]
    v_exp_f32 v125, v125
    v_exp_f32 v126, v126
    v_exp_f32 v127, v127
    s_waitcnt vmcnt(15) lgkmcnt(2)
    v_mfma_f32_32x32x16_bf16 v[72:87], v[32:35], a[4:7], v[72:87]
    ds_read_b128 v[24:27], v117 offset:22528
    ds_read_b128 v[28:31], v118 offset:22528
    v_exp_f32 v128, v128
    v_exp_f32 v129, v129
    v_exp_f32 v130, v130
    v_mfma_f32_32x32x16_bf16 v[88:103], v[36:39], a[4:7], v[88:103]
    v_exp_f32 v131, v131
    v_exp_f32 v132, v132
    v_exp_f32 v133, v133
    s_waitcnt vmcnt(13) lgkmcnt(2)
    s_waitcnt vmcnt(0)
    s_barrier
    v_mfma_f32_32x32x16_bf16 v[72:87], v[16:19], a[8:11], v[72:87]
    ds_read_b128 v[32:35], v117 offset:32768
    ds_read_b128 v[36:39], v118 offset:32768
    v_exp_f32 v134, v134
    v_exp_f32 v135, v135
    v_add_f32 v120, 1.0, v120
    v_mfma_f32_32x32x16_bf16 v[88:103], v[20:23], a[8:11], v[88:103]
    v_add_f32 v121, 1.0, v121
    v_add_f32 v122, 1.0, v122
    v_add_f32 v123, 1.0, v123
    v_add_f32 v124, 1.0, v124
    v_add_f32 v125, 1.0, v125
    s_waitcnt vmcnt(11) lgkmcnt(2)
    v_mfma_f32_32x32x16_bf16 v[72:87], v[24:27], a[12:15], v[72:87]
    ds_read_b128 v[16:19], v117 offset:34816
    ds_read_b128 v[20:23], v118 offset:34816
    v_add_f32 v126, 1.0, v126
    v_add_f32 v127, 1.0, v127
    v_add_f32 v128, 1.0, v128
    v_add_f32 v129, 1.0, v129
    v_add_f32 v130, 1.0, v130
    v_mfma_f32_32x32x16_bf16 v[88:103], v[28:31], a[12:15], v[88:103]
    v_add_f32 v131, 1.0, v131
    v_add_f32 v132, 1.0, v132
    v_add_f32 v133, 1.0, v133
    v_add_f32 v134, 1.0, v134
    v_add_f32 v135, 1.0, v135
    s_waitcnt vmcnt(9) lgkmcnt(2)
    v_mfma_f32_32x32x16_bf16 v[72:87], v[32:35], a[16:19], v[72:87]
    ds_read_b128 v[24:27], v117 offset:36864
    ds_read_b128 v[28:31], v118 offset:36864
    v_rcp_f32 v120, v120
    v_lshlrev_b32 v152, 16, v224
    v_rcp_f32 v121, v121
    v_mfma_f32_32x32x16_bf16 v[88:103], v[36:39], a[16:19], v[88:103]
    v_and_b32 v153, 0xffff0000, v224
    v_rcp_f32 v122, v122
    v_lshlrev_b32 v154, 16, v225
    v_rcp_f32 v123, v123
    s_waitcnt vmcnt(7) lgkmcnt(2)
    v_mfma_f32_32x32x16_bf16 v[72:87], v[16:19], a[20:23], v[72:87]
    ds_read_b128 v[32:35], v117 offset:38912
    ds_read_b128 v[36:39], v118 offset:38912
    v_and_b32 v155, 0xffff0000, v225
    v_rcp_f32 v124, v124
    v_lshlrev_b32 v156, 16, v226
    v_rcp_f32 v125, v125
    v_mfma_f32_32x32x16_bf16 v[88:103], v[20:23], a[20:23], v[88:103]
    v_and_b32 v157, 0xffff0000, v226
    v_rcp_f32 v126, v126
    v_lshlrev_b32 v158, 16, v227
    v_rcp_f32 v127, v127
    s_waitcnt vmcnt(5) lgkmcnt(2)
    v_mfma_f32_32x32x16_bf16 v[72:87], v[24:27], a[24:27], v[72:87]
    v_and_b32 v159, 0xffff0000, v227
    v_rcp_f32 v128, v128
    v_lshlrev_b32 v160, 16, v228
    v_rcp_f32 v129, v129
    v_mfma_f32_32x32x16_bf16 v[88:103], v[28:31], a[24:27], v[88:103]
    v_and_b32 v161, 0xffff0000, v228
    v_rcp_f32 v130, v130
    v_lshlrev_b32 v162, 16, v229
    v_rcp_f32 v131, v131
    s_waitcnt vmcnt(3) lgkmcnt(0)
    v_mfma_f32_32x32x16_bf16 v[88:103], v[36:39], a[28:31], v[88:103]
    v_and_b32 v163, 0xffff0000, v229
    v_rcp_f32 v132, v132
    v_lshlrev_b32 v164, 16, v230
    v_rcp_f32 v133, v133
    v_mfma_f32_32x32x16_bf16 v[72:87], v[32:35], a[28:31], v[72:87]
    v_and_b32 v165, 0xffff0000, v230
    v_rcp_f32 v134, v134
    v_lshlrev_b32 v166, 16, v231
    v_rcp_f32 v135, v135
    v_and_b32 v167, 0xffff0000, v231
    v_mul_f32 v40, v40, v120
    v_mul_f32 v41, v41, v121
    v_mul_f32 v42, v42, v122
    v_mul_f32 v43, v43, v123
    v_mul_f32 v44, v44, v124
    v_mul_f32 v45, v45, v125
    v_mul_f32 v46, v46, v126
    v_mul_f32 v47, v47, v127
    v_mul_f32 v48, v48, v128
    ds_write_b128 v6, v[88:91] offset:0
    ds_write_b128 v6, v[92:95] offset:1024
    ds_write_b128 v6, v[96:99] offset:2048
    ds_write_b128 v6, v[100:103] offset:3072
    v_mul_f32 v49, v49, v129
    v_mul_f32 v50, v50, v130
    v_mul_f32 v51, v51, v131
    v_mul_f32 v52, v52, v132
    v_mul_f32 v53, v53, v133
    v_mul_f32 v54, v54, v134
    v_mul_f32 v55, v55, v135
    s_waitcnt lgkmcnt(0)
    s_barrier
    ds_read_b128 v[168:171], v7 offset:0
    ds_read_b128 v[172:175], v7 offset:1024
    ds_read_b128 v[176:179], v7 offset:2048
    ds_read_b128 v[180:183], v7 offset:3072
    s_waitcnt lgkmcnt(3)
    v_pk_add_f32 v[72:73], v[72:73], v[168:169]
    v_pk_add_f32 v[74:75], v[74:75], v[170:171]
    v_pk_fma_f32 v[72:73], v[72:73], v[40:41], v[152:153]
    v_pk_fma_f32 v[74:75], v[74:75], v[42:43], v[154:155]
    v_cvt_pk_bf16_f32 v184, v72, v73
    v_cvt_pk_bf16_f32 v185, v74, v75
    s_waitcnt lgkmcnt(2)
    v_pk_add_f32 v[76:77], v[76:77], v[172:173]
    v_pk_add_f32 v[78:79], v[78:79], v[174:175]
    v_pk_fma_f32 v[76:77], v[76:77], v[44:45], v[156:157]
    v_pk_fma_f32 v[78:79], v[78:79], v[46:47], v[158:159]
    v_cvt_pk_bf16_f32 v186, v76, v77
    v_cvt_pk_bf16_f32 v187, v78, v79
    s_nop 0
    v_permlane32_swap_b32 v184, v186
    s_nop 0
    v_permlane32_swap_b32 v185, v187
    buffer_store_dwordx4 v[184:187], v116, s[28:31], s73 offen offset:0
    s_waitcnt lgkmcnt(1)
    v_pk_add_f32 v[80:81], v[80:81], v[176:177]
    v_pk_add_f32 v[82:83], v[82:83], v[178:179]
    v_pk_fma_f32 v[80:81], v[80:81], v[48:49], v[160:161]
    v_pk_fma_f32 v[82:83], v[82:83], v[50:51], v[162:163]
    v_cvt_pk_bf16_f32 v188, v80, v81
    v_cvt_pk_bf16_f32 v189, v82, v83
    s_waitcnt lgkmcnt(0)
    v_pk_add_f32 v[84:85], v[84:85], v[180:181]
    v_pk_add_f32 v[86:87], v[86:87], v[182:183]
    v_pk_fma_f32 v[84:85], v[84:85], v[52:53], v[164:165]
    v_pk_fma_f32 v[86:87], v[86:87], v[54:55], v[166:167]
    v_cvt_pk_bf16_f32 v190, v84, v85
    v_cvt_pk_bf16_f32 v191, v86, v87
    s_nop 0
    v_permlane32_swap_b32 v188, v190
    s_nop 0
    v_permlane32_swap_b32 v189, v191
    buffer_store_dwordx4 v[188:191], v116, s[28:31], s73 offen offset:32
    s_endpgm
L_slow:
    s_waitcnt vmcnt(0)
    s_add_u32 s36, s101, 17836032
    v_mov_b32 v3, s47
    v_mov_b32 v2, 0
    s_mov_b64 exec, 1
    buffer_store_dword v3, v2, s[32:35], s36 offen sc1
    s_mov_b64 exec, -1
    s_add_u32 m0, s72, 65536
    s_add_u32 s68, s68, 16384
    buffer_load_dwordx4 v252, s[24:27], s68 offen lds
    s_add_u32 m0, s72, 67584
    s_add_u32 s68, s68, 16384
    buffer_load_dwordx4 v252, s[24:27], s68 offen lds
    s_add_u32 m0, s72, 69632
    s_add_u32 s68, s68, 16384
    buffer_load_dwordx4 v252, s[24:27], s68 offen lds
    s_add_u32 m0, s72, 71680
    s_add_u32 s68, s68, 16384
    buffer_load_dwordx4 v252, s[24:27], s68 offen lds
    s_add_u32 m0, s72, 81920
    s_add_u32 s68, s68, 16384
    buffer_load_dwordx4 v252, s[24:27], s68 offen lds
    s_add_u32 m0, s72, 83968
    s_add_u32 s68, s68, 16384
    buffer_load_dwordx4 v252, s[24:27], s68 offen lds
    s_add_u32 m0, s72, 86016
    s_add_u32 s68, s68, 16384
    buffer_load_dwordx4 v252, s[24:27], s68 offen lds
    s_add_u32 m0, s72, 88064
    s_add_u32 s68, s68, 16384
    buffer_load_dwordx4 v252, s[24:27], s68 offen lds
    s_add_u32 m0, s72, 98304
    s_add_u32 s68, s68, 16384
    buffer_load_dwordx4 v252, s[24:27], s68 offen lds
    s_add_u32 m0, s72, 100352
    s_add_u32 s68, s68, 16384
    buffer_load_dwordx4 v252, s[24:27], s68 offen lds
    s_add_u32 m0, s72, 102400
    s_add_u32 s68, s68, 16384
    buffer_load_dwordx4 v252, s[24:27], s68 offen lds
    s_add_u32 m0, s72, 104448
    s_add_u32 s68, s68, 16384
    buffer_load_dwordx4 v252, s[24:27], s68 offen lds
    s_add_u32 m0, s72, 114688
    s_add_u32 s68, s68, 16384
    buffer_load_dwordx4 v252, s[24:27], s68 offen lds
    s_add_u32 m0, s72, 116736
    s_add_u32 s68, s68, 16384
    buffer_load_dwordx4 v252, s[24:27], s68 offen lds
    s_add_u32 m0, s72, 118784
    s_add_u32 s68, s68, 16384
    buffer_load_dwordx4 v252, s[24:27], s68 offen lds
    s_add_u32 m0, s72, 120832
    s_add_u32 s68, s68, 16384
    buffer_load_dwordx4 v252, s[24:27], s68 offen lds
    v_and_b32 v2, 31, v1
    v_lshrrev_b32 v3, 5, v1
    v_lshlrev_b32 v4, 2, v3
    v_mov_b32 v5, 0xff7fffff
    v_mov_b32 v6, 0
    v_add_u32 v7, 0, v4
    v_cmp_gt_u32 vcc, v7, v2
    s_nop 1
    v_cndmask_b32 v152, v5, v6, vcc
    v_cndmask_b32 v168, v6, v5, vcc
    v_add_u32 v7, 1, v4
    v_cmp_gt_u32 vcc, v7, v2
    s_nop 1
    v_cndmask_b32 v153, v5, v6, vcc
    v_cndmask_b32 v169, v6, v5, vcc
    v_add_u32 v7, 2, v4
    v_cmp_gt_u32 vcc, v7, v2
    s_nop 1
    v_cndmask_b32 v154, v5, v6, vcc
    v_cndmask_b32 v170, v6, v5, vcc
    v_add_u32 v7, 3, v4
    v_cmp_gt_u32 vcc, v7, v2
    s_nop 1
    v_cndmask_b32 v155, v5, v6, vcc
    v_cndmask_b32 v171, v6, v5, vcc
    v_add_u32 v7, 8, v4
    v_cmp_gt_u32 vcc, v7, v2
    s_nop 1
    v_cndmask_b32 v156, v5, v6, vcc
    v_cndmask_b32 v172, v6, v5, vcc
    v_add_u32 v7, 9, v4
    v_cmp_gt_u32 vcc, v7, v2
    s_nop 1
    v_cndmask_b32 v157, v5, v6, vcc
    v_cndmask_b32 v173, v6, v5, vcc
    v_add_u32 v7, 10, v4
    v_cmp_gt_u32 vcc, v7, v2
    s_nop 1
    v_cndmask_b32 v158, v5, v6, vcc
    v_cndmask_b32 v174, v6, v5, vcc
    v_add_u32 v7, 11, v4
    v_cmp_gt_u32 vcc, v7, v2
    s_nop 1
    v_cndmask_b32 v159, v5, v6, vcc
    v_cndmask_b32 v175, v6, v5, vcc
    v_add_u32 v7, 16, v4
    v_cmp_gt_u32 vcc, v7, v2
    s_nop 1
    v_cndmask_b32 v160, v5, v6, vcc
    v_cndmask_b32 v176, v6, v5, vcc
    v_add_u32 v7, 17, v4
    v_cmp_gt_u32 vcc, v7, v2
    s_nop 1
    v_cndmask_b32 v161, v5, v6, vcc
    v_cndmask_b32 v177, v6, v5, vcc
    v_add_u32 v7, 18, v4
    v_cmp_gt_u32 vcc, v7, v2
    s_nop 1
    v_cndmask_b32 v162, v5, v6, vcc
    v_cndmask_b32 v178, v6, v5, vcc
    v_add_u32 v7, 19, v4
    v_cmp_gt_u32 vcc, v7, v2
    s_nop 1
    v_cndmask_b32 v163, v5, v6, vcc
    v_cndmask_b32 v179, v6, v5, vcc
    v_add_u32 v7, 24, v4
    v_cmp_gt_u32 vcc, v7, v2
    s_nop 1
    v_cndmask_b32 v164, v5, v6, vcc
    v_cndmask_b32 v180, v6, v5, vcc
    v_add_u32 v7, 25, v4
    v_cmp_gt_u32 vcc, v7, v2
    s_nop 1
    v_cndmask_b32 v165, v5, v6, vcc
    v_cndmask_b32 v181, v6, v5, vcc
    v_add_u32 v7, 26, v4
    v_cmp_gt_u32 vcc, v7, v2
    s_nop 1
    v_cndmask_b32 v166, v5, v6, vcc
    v_cndmask_b32 v182, v6, v5, vcc
    v_add_u32 v7, 27, v4
    v_cmp_gt_u32 vcc, v7, v2
    s_nop 1
    v_cndmask_b32 v167, v5, v6, vcc
    v_cndmask_b32 v183, v6, v5, vcc
    v_cmp_eq_u32 vcc, 0, v152
    v_mov_b32 v7, 0xffff
    s_nop 0
    v_cndmask_b32 v184, 0, v7, vcc
    v_cmp_eq_u32 vcc, 0, v153
    v_mov_b32 v7, 0xffff0000
    s_nop 0
    v_cndmask_b32 v7, 0, v7, vcc
    v_or_b32 v184, v184, v7
    v_cmp_eq_u32 vcc, 0, v154
    v_mov_b32 v7, 0xffff
    s_nop 0
    v_cndmask_b32 v185, 0, v7, vcc
    v_cmp_eq_u32 vcc, 0, v155
    v_mov_b32 v7, 0xffff0000
    s_nop 0
    v_cndmask_b32 v7, 0, v7, vcc
    v_or_b32 v185, v185, v7
    v_cmp_eq_u32 vcc, 0, v156
    v_mov_b32 v7, 0xffff
    s_nop 0
    v_cndmask_b32 v186, 0, v7, vcc
    v_cmp_eq_u32 vcc, 0, v157
    v_mov_b32 v7, 0xffff0000
    s_nop 0
    v_cndmask_b32 v7, 0, v7, vcc
    v_or_b32 v186, v186, v7
    v_cmp_eq_u32 vcc, 0, v158
    v_mov_b32 v7, 0xffff
    s_nop 0
    v_cndmask_b32 v187, 0, v7, vcc
    v_cmp_eq_u32 vcc, 0, v159
    v_mov_b32 v7, 0xffff0000
    s_nop 0
    v_cndmask_b32 v7, 0, v7, vcc
    v_or_b32 v187, v187, v7
    v_cmp_eq_u32 vcc, 0, v160
    v_mov_b32 v7, 0xffff
    s_nop 0
    v_cndmask_b32 v188, 0, v7, vcc
    v_cmp_eq_u32 vcc, 0, v161
    v_mov_b32 v7, 0xffff0000
    s_nop 0
    v_cndmask_b32 v7, 0, v7, vcc
    v_or_b32 v188, v188, v7
    v_cmp_eq_u32 vcc, 0, v162
    v_mov_b32 v7, 0xffff
    s_nop 0
    v_cndmask_b32 v189, 0, v7, vcc
    v_cmp_eq_u32 vcc, 0, v163
    v_mov_b32 v7, 0xffff0000
    s_nop 0
    v_cndmask_b32 v7, 0, v7, vcc
    v_or_b32 v189, v189, v7
    v_cmp_eq_u32 vcc, 0, v164
    v_mov_b32 v7, 0xffff
    s_nop 0
    v_cndmask_b32 v190, 0, v7, vcc
    v_cmp_eq_u32 vcc, 0, v165
    v_mov_b32 v7, 0xffff0000
    s_nop 0
    v_cndmask_b32 v7, 0, v7, vcc
    v_or_b32 v190, v190, v7
    v_cmp_eq_u32 vcc, 0, v166
    v_mov_b32 v7, 0xffff
    s_nop 0
    v_cndmask_b32 v191, 0, v7, vcc
    v_cmp_eq_u32 vcc, 0, v167
    v_mov_b32 v7, 0xffff0000
    s_nop 0
    v_cndmask_b32 v7, 0, v7, vcc
    v_or_b32 v191, v191, v7
    v_mov_b32 v4, 0x3f803f80
    v_mov_b32 v5, 0x3f803f80
    v_mov_b32 v6, 0x3f803f80
    v_mov_b32 v7, 0x3f803f80
    v_lshlrev_b32 v2, 4, v1
    v_add_u32 v2, 159744, v2
    ds_write_b128 v2, v[4:7]
    ds_write_b128 v2, v[4:7] offset:1024
    v_and_b32 v2, 31, v1
    v_lshrrev_b32 v3, 5, v1
    v_bfe_u32 v4, v2, 3, 1
    v_xor_b32 v3, v3, v4
    v_lshl_add_u32 v3, v2, 1, v3
    v_lshlrev_b32 v3, 4, v3
    s_add_u32 s36, s6, 8
    s_mul_i32 s36, s36, 2048
    s_add_u32 s37, s36, 0
    v_add_u32 v196, s37, v3
    v_bfe_u32 v2, v1, 2, 2
    v_lshrrev_b32 v3, 5, v1
    v_lshl_add_u32 v2, v3, 2, v2
    v_lshlrev_b32 v2, 5, v2
    v_and_b32 v4, 1, v1
    v_lshl_add_u32 v5, v4, 4, v2
    v_bfe_u32 v6, v1, 1, 1
    v_lshl_add_u32 v5, v6, 3, v5
    v_xor_b32 v6, 16, v5
    v_add_u32 v6, 256, v6
    s_add_u32 s37, s36, 24576
    v_add_u32 v5, s37, v5
    v_add_u32 v6, s37, v6
    v_xor_b32 v3, 1, v3
    v_lshlrev_b32 v3, 7, v3
    v_add_u32 v3, 159744, v3
    v_bfe_u32 v4, v1, 4, 1
    v_cmp_eq_u32 vcc, 1, v4
    v_mov_b32 v7, 0xfffff800
    s_nop 0
    v_cndmask_b32 v197, v5, v3, vcc
    v_cndmask_b32 v198, v6, v3, vcc
    v_cndmask_b32 v195, v7, 0, vcc
    s_lshl_b32 s74, s4, 2
    s_add_u32 s74, s74, s6
    s_cmp_ge_u32 s74, 8
    s_cselect_b32 s77, 1, 0
    s_cselect_b32 s76, 7, s74
    s_waitcnt lgkmcnt(0)
    v_mov_b32 v192, v196
    v_mov_b32 v199, 0xff7fffff
    v_mov_b32 v200, 0xff7fffff
    ds_read_b128 v[16:19], v192 offset:0
    ds_read_b128 v[20:23], v192 offset:1024
    s_waitcnt lgkmcnt(0)
    v_mfma_f32_32x32x16_bf16 v[40:55], v[16:19], v[8:11], v[168:183]
    v_mfma_f32_32x32x16_bf16 v[56:71], v[20:23], v[12:15], v[168:183]
    v_add_u32 v192, 0xfffff800, v192
    ds_read_b128 v[16:19], v192 offset:0
    ds_read_b128 v[20:23], v192 offset:1024
    s_mov_b32 s78, s76
    s_cmp_eq_u32 s78, 0
    s_nop 7
    s_cbranch_scc1 L_a1_mid_done
L_a1_mid:
    v_max3_f32 v199, v199, v40, v41
    v_max3_f32 v199, v199, v42, v43
    v_max3_f32 v199, v199, v44, v45
    v_max3_f32 v199, v199, v46, v47
    v_max3_f32 v199, v199, v48, v49
    v_max3_f32 v199, v199, v50, v51
    v_max3_f32 v199, v199, v52, v53
    v_max3_f32 v199, v199, v54, v55
    s_waitcnt lgkmcnt(0)
    v_mfma_f32_32x32x16_bf16 v[40:55], v[16:19], v[8:11], 0
    v_max3_f32 v200, v200, v56, v57
    v_max3_f32 v200, v200, v58, v59
    v_max3_f32 v200, v200, v60, v61
    v_max3_f32 v200, v200, v62, v63
    v_max3_f32 v200, v200, v64, v65
    v_max3_f32 v200, v200, v66, v67
    v_max3_f32 v200, v200, v68, v69
    v_max3_f32 v200, v200, v70, v71
    v_mfma_f32_32x32x16_bf16 v[56:71], v[20:23], v[12:15], 0
    v_add_u32 v192, 0xfffff800, v192
    ds_read_b128 v[16:19], v192 offset:0
    ds_read_b128 v[20:23], v192 offset:1024
    s_sub_u32 s78, s78, 1
    s_cmp_lg_u32 s78, 0
    s_cbranch_scc1 L_a1_mid
L_a1_mid_done:
    s_cmp_eq_u32 s77, 0
    s_cbranch_scc1 L_a1_nofar
    v_max3_f32 v199, v199, v40, v41
    v_max3_f32 v199, v199, v42, v43
    v_max3_f32 v199, v199, v44, v45
    v_max3_f32 v199, v199, v46, v47
    v_max3_f32 v199, v199, v48, v49
    v_max3_f32 v199, v199, v50, v51
    v_max3_f32 v199, v199, v52, v53
    v_max3_f32 v199, v199, v54, v55
    s_waitcnt lgkmcnt(0)
    v_mfma_f32_32x32x16_bf16 v[40:55], v[16:19], v[8:11], v[152:167]
    v_max3_f32 v200, v200, v56, v57
    v_max3_f32 v200, v200, v58, v59
    v_max3_f32 v200, v200, v60, v61
    v_max3_f32 v200, v200, v62, v63
    v_max3_f32 v200, v200, v64, v65
    v_max3_f32 v200, v200, v66, v67
    v_max3_f32 v200, v200, v68, v69
    v_max3_f32 v200, v200, v70, v71
    v_mfma_f32_32x32x16_bf16 v[56:71], v[20:23], v[12:15], v[152:167]
    v_add_u32 v192, 0xfffff800, v192
    ds_read_b128 v[16:19], v192 offset:0
    ds_read_b128 v[20:23], v192 offset:1024
    s_nop 3
L_a1_nofar:
    v_max3_f32 v199, v199, v40, v41
    v_max3_f32 v199, v199, v42, v43
    v_max3_f32 v199, v199, v44, v45
    v_max3_f32 v199, v199, v46, v47
    v_max3_f32 v199, v199, v48, v49
    v_max3_f32 v199, v199, v50, v51
    v_max3_f32 v199, v199, v52, v53
    v_max3_f32 v199, v199, v54, v55
    v_max3_f32 v200, v200, v56, v57
    v_max3_f32 v200, v200, v58, v59
    v_max3_f32 v200, v200, v60, v61
    v_max3_f32 v200, v200, v62, v63
    v_max3_f32 v200, v200, v64, v65
    v_max3_f32 v200, v200, v66, v67
    v_max3_f32 v200, v200, v68, v69
    v_max3_f32 v200, v200, v70, v71
    v_mov_b32 v2, v199
    s_nop 1
    v_permlane32_swap_b32 v2, v199
    s_nop 1
    v_max_f32 v199, v199, v2
    v_sub_f32 v199, 0, v199
    v_mov_b32 v120, v199
    v_mov_b32 v121, v199
    v_mov_b32 v122, v199
    v_mov_b32 v123, v199
    v_mov_b32 v124, v199
    v_mov_b32 v125, v199
    v_mov_b32 v126, v199
    v_mov_b32 v127, v199
    v_mov_b32 v128, v199
    v_mov_b32 v129, v199
    v_mov_b32 v130, v199
    v_mov_b32 v131, v199
    v_mov_b32 v132, v199
    v_mov_b32 v133, v199
    v_mov_b32 v134, v199
    v_mov_b32 v135, v199
    v_mov_b32 v2, v200
    s_nop 1
    v_permlane32_swap_b32 v2, v200
    s_nop 1
    v_max_f32 v200, v200, v2
    v_sub_f32 v200, 0, v200
    v_mov_b32 v136, v200
    v_mov_b32 v137, v200
    v_mov_b32 v138, v200
    v_mov_b32 v139, v200
    v_mov_b32 v140, v200
    v_mov_b32 v141, v200
    v_mov_b32 v142, v200
    v_mov_b32 v143, v200
    v_mov_b32 v144, v200
    v_mov_b32 v145, v200
    v_mov_b32 v146, v200
    v_mov_b32 v147, v200
    v_mov_b32 v148, v200
    v_mov_b32 v149, v200
    v_mov_b32 v150, v200
    v_mov_b32 v151, v200
    v_mov_b32 v88, 0
    v_mov_b32 v104, 0
    v_mov_b32 v89, 0
    v_mov_b32 v105, 0
    v_mov_b32 v90, 0
    v_mov_b32 v106, 0
    v_mov_b32 v91, 0
    v_mov_b32 v107, 0
    v_mov_b32 v92, 0
    v_mov_b32 v108, 0
    v_mov_b32 v93, 0
    v_mov_b32 v109, 0
    v_mov_b32 v94, 0
    v_mov_b32 v110, 0
    v_mov_b32 v95, 0
    v_mov_b32 v111, 0
    v_mov_b32 v96, 0
    v_mov_b32 v112, 0
    v_mov_b32 v97, 0
    v_mov_b32 v113, 0
    v_mov_b32 v98, 0
    v_mov_b32 v114, 0
    v_mov_b32 v99, 0
    v_mov_b32 v115, 0
    v_mov_b32 v100, 0
    v_mov_b32 v116, 0
    v_mov_b32 v101, 0
    v_mov_b32 v117, 0
    v_mov_b32 v102, 0
    v_mov_b32 v118, 0
    v_mov_b32 v103, 0
    v_mov_b32 v119, 0
    v_mov_b32 v80, 0
    v_mov_b32 v32, 0
    v_mov_b32 v81, 0
    v_mov_b32 v33, 0
    v_mov_b32 v82, 0
    v_mov_b32 v34, 0
    v_mov_b32 v83, 0
    v_mov_b32 v35, 0
    v_mov_b32 v84, 0
    v_mov_b32 v36, 0
    v_mov_b32 v85, 0
    v_mov_b32 v37, 0
    v_mov_b32 v86, 0
    v_mov_b32 v38, 0
    v_mov_b32 v87, 0
    v_mov_b32 v39, 0
    v_mov_b32 v192, v196
    v_mov_b32 v193, v197
    v_mov_b32 v194, v198
    ds_read_b128 v[16:19], v192 offset:0
    ds_read_b128 v[20:23], v192 offset:1024
    s_waitcnt lgkmcnt(0)
    v_mfma_f32_32x32x16_bf16 v[40:55], v[16:19], v[8:11], v[120:135]
    v_add_u32 v192, 0xfffff800, v192
    s_nop 7
    s_nop 1
    s_waitcnt lgkmcnt(0)
    v_mfma_f32_32x32x16_bf16 v[56:71], v[20:23], v[12:15], v[136:151]
    v_exp_f32 v40, v40
    ds_read_b64_tr_b16 v[24:25], v193 offset:0
    v_exp_f32 v41, v41
    ds_read_b64_tr_b16 v[26:27], v194 offset:0
    v_exp_f32 v42, v42
    v_cvt_pk_bf16_f32 v72, v40, v41
    v_exp_f32 v43, v43
    ds_read_b64_tr_b16 v[28:29], v193 offset:512
    v_exp_f32 v44, v44
    v_cvt_pk_bf16_f32 v73, v42, v43
    v_mfma_f32_32x32x16_bf16 v[104:119], v[32:35], v[80:83], v[104:119]
    v_exp_f32 v45, v45
    ds_read_b64_tr_b16 v[30:31], v194 offset:512
    v_exp_f32 v46, v46
    v_cvt_pk_bf16_f32 v74, v44, v45
    v_exp_f32 v47, v47
    ds_read_b128 v[16:19], v192 offset:0
    v_exp_f32 v48, v48
    v_cvt_pk_bf16_f32 v75, v46, v47
    v_mfma_f32_32x32x16_bf16 v[104:119], v[36:39], v[84:87], v[104:119]
    v_exp_f32 v49, v49
    v_exp_f32 v50, v50
    v_cvt_pk_bf16_f32 v76, v48, v49
    v_exp_f32 v51, v51
    v_exp_f32 v52, v52
    v_cvt_pk_bf16_f32 v77, v50, v51
    v_exp_f32 v53, v53
    v_exp_f32 v54, v54
    v_cvt_pk_bf16_f32 v78, v52, v53
    v_exp_f32 v55, v55
    s_nop 0
    v_cvt_pk_bf16_f32 v79, v54, v55
    v_bfi_b32 v72, v184, 0, v72
    v_bfi_b32 v73, v185, 0, v73
    v_bfi_b32 v74, v186, 0, v74
    v_bfi_b32 v75, v187, 0, v75
    v_bfi_b32 v76, v188, 0, v76
    v_bfi_b32 v77, v189, 0, v77
    v_bfi_b32 v78, v190, 0, v78
    v_bfi_b32 v79, v191, 0, v79
    s_waitcnt lgkmcnt(0)
    v_mfma_f32_32x32x16_bf16 v[40:55], v[16:19], v[8:11], v[120:135]
    v_exp_f32 v56, v56
    ds_read_b64_tr_b16 v[32:33], v193 offset:1024
    v_exp_f32 v57, v57
    ds_read_b64_tr_b16 v[34:35], v194 offset:1024
    v_exp_f32 v58, v58
    v_cvt_pk_bf16_f32 v80, v56, v57
    v_exp_f32 v59, v59
    ds_read_b64_tr_b16 v[36:37], v193 offset:1536
    v_exp_f32 v60, v60
    v_cvt_pk_bf16_f32 v81, v58, v59
    v_mfma_f32_32x32x16_bf16 v[88:103], v[24:27], v[72:75], v[88:103]
    v_exp_f32 v61, v61
    ds_read_b64_tr_b16 v[38:39], v194 offset:1536
    v_exp_f32 v62, v62
    v_cvt_pk_bf16_f32 v82, v60, v61
    v_exp_f32 v63, v63
    ds_read_b128 v[20:23], v192 offset:1024
    v_exp_f32 v64, v64
    v_cvt_pk_bf16_f32 v83, v62, v63
    v_mfma_f32_32x32x16_bf16 v[88:103], v[28:31], v[76:79], v[88:103]
    v_exp_f32 v65, v65
    v_add_u32 v192, 0xfffff800, v192
    v_exp_f32 v66, v66
    v_cvt_pk_bf16_f32 v84, v64, v65
    v_exp_f32 v67, v67
    v_add_u32 v193, v195, v193
    v_exp_f32 v68, v68
    v_cvt_pk_bf16_f32 v85, v66, v67
    v_exp_f32 v69, v69
    v_add_u32 v194, v195, v194
    v_exp_f32 v70, v70
    v_cvt_pk_bf16_f32 v86, v68, v69
    v_exp_f32 v71, v71
    s_nop 0
    v_cvt_pk_bf16_f32 v87, v70, v71
    v_bfi_b32 v80, v184, 0, v80
    v_bfi_b32 v81, v185, 0, v81
    v_bfi_b32 v82, v186, 0, v82
    v_bfi_b32 v83, v187, 0, v83
    v_bfi_b32 v84, v188, 0, v84
    v_bfi_b32 v85, v189, 0, v85
    v_bfi_b32 v86, v190, 0, v86
    v_bfi_b32 v87, v191, 0, v87
    s_mov_b32 s78, s76
    s_cmp_eq_u32 s78, 0
    s_cbranch_scc1 L_a2_mid_done
L_a2_mid:
    s_waitcnt lgkmcnt(0)
    v_mfma_f32_32x32x16_bf16 v[56:71], v[20:23], v[12:15], v[136:151]
    v_exp_f32 v40, v40
    ds_read_b64_tr_b16 v[24:25], v193 offset:0
    v_exp_f32 v41, v41
    ds_read_b64_tr_b16 v[26:27], v194 offset:0
    v_exp_f32 v42, v42
    v_cvt_pk_bf16_f32 v72, v40, v41
    v_exp_f32 v43, v43
    ds_read_b64_tr_b16 v[28:29], v193 offset:512
    v_exp_f32 v44, v44
    v_cvt_pk_bf16_f32 v73, v42, v43
    v_mfma_f32_32x32x16_bf16 v[104:119], v[32:35], v[80:83], v[104:119]
    v_exp_f32 v45, v45
    ds_read_b64_tr_b16 v[30:31], v194 offset:512
    v_exp_f32 v46, v46
    v_cvt_pk_bf16_f32 v74, v44, v45
    v_exp_f32 v47, v47
    ds_read_b128 v[16:19], v192 offset:0
    v_exp_f32 v48, v48
    v_cvt_pk_bf16_f32 v75, v46, v47
    v_mfma_f32_32x32x16_bf16 v[104:119], v[36:39], v[84:87], v[104:119]
    v_exp_f32 v49, v49
    v_exp_f32 v50, v50
    v_cvt_pk_bf16_f32 v76, v48, v49
    v_exp_f32 v51, v51
    v_exp_f32 v52, v52
    v_cvt_pk_bf16_f32 v77, v50, v51
    v_exp_f32 v53, v53
    v_exp_f32 v54, v54
    v_cvt_pk_bf16_f32 v78, v52, v53
    v_exp_f32 v55, v55
    s_nop 0
    v_cvt_pk_bf16_f32 v79, v54, v55
    s_waitcnt lgkmcnt(0)
    v_mfma_f32_32x32x16_bf16 v[40:55], v[16:19], v[8:11], v[120:135]
    v_exp_f32 v56, v56
    ds_read_b64_tr_b16 v[32:33], v193 offset:1024
    v_exp_f32 v57, v57
    ds_read_b64_tr_b16 v[34:35], v194 offset:1024
    v_exp_f32 v58, v58
    v_cvt_pk_bf16_f32 v80, v56, v57
    v_exp_f32 v59, v59
    ds_read_b64_tr_b16 v[36:37], v193 offset:1536
    v_exp_f32 v60, v60
    v_cvt_pk_bf16_f32 v81, v58, v59
    v_mfma_f32_32x32x16_bf16 v[88:103], v[24:27], v[72:75], v[88:103]
    v_exp_f32 v61, v61
    ds_read_b64_tr_b16 v[38:39], v194 offset:1536
    v_exp_f32 v62, v62
    v_cvt_pk_bf16_f32 v82, v60, v61
    v_exp_f32 v63, v63
    ds_read_b128 v[20:23], v192 offset:1024
    v_exp_f32 v64, v64
    v_cvt_pk_bf16_f32 v83, v62, v63
    v_mfma_f32_32x32x16_bf16 v[88:103], v[28:31], v[76:79], v[88:103]
    v_exp_f32 v65, v65
    v_add_u32 v192, 0xfffff800, v192
    v_exp_f32 v66, v66
    v_cvt_pk_bf16_f32 v84, v64, v65
    v_exp_f32 v67, v67
    v_add_u32 v193, v195, v193
    v_exp_f32 v68, v68
    v_cvt_pk_bf16_f32 v85, v66, v67
    v_exp_f32 v69, v69
    v_add_u32 v194, v195, v194
    v_exp_f32 v70, v70
    v_cvt_pk_bf16_f32 v86, v68, v69
    v_exp_f32 v71, v71
    s_nop 0
    v_cvt_pk_bf16_f32 v87, v70, v71
    s_sub_u32 s78, s78, 1
    s_cmp_lg_u32 s78, 0
    s_cbranch_scc1 L_a2_mid
L_a2_mid_done:
    s_cmp_eq_u32 s77, 0
    s_cbranch_scc1 L_a2_nofar
    s_waitcnt lgkmcnt(0)
    v_mfma_f32_32x32x16_bf16 v[56:71], v[20:23], v[12:15], v[136:151]
    v_exp_f32 v40, v40
    ds_read_b64_tr_b16 v[24:25], v193 offset:0
    v_exp_f32 v41, v41
    ds_read_b64_tr_b16 v[26:27], v194 offset:0
    v_exp_f32 v42, v42
    v_cvt_pk_bf16_f32 v72, v40, v41
    v_exp_f32 v43, v43
    ds_read_b64_tr_b16 v[28:29], v193 offset:512
    v_exp_f32 v44, v44
    v_cvt_pk_bf16_f32 v73, v42, v43
    v_mfma_f32_32x32x16_bf16 v[104:119], v[32:35], v[80:83], v[104:119]
    v_exp_f32 v45, v45
    ds_read_b64_tr_b16 v[30:31], v194 offset:512
    v_exp_f32 v46, v46
    v_cvt_pk_bf16_f32 v74, v44, v45
    v_exp_f32 v47, v47
    ds_read_b128 v[16:19], v192 offset:0
    v_exp_f32 v48, v48
    v_cvt_pk_bf16_f32 v75, v46, v47
    v_mfma_f32_32x32x16_bf16 v[104:119], v[36:39], v[84:87], v[104:119]
    v_exp_f32 v49, v49
    v_exp_f32 v50, v50
    v_cvt_pk_bf16_f32 v76, v48, v49
    v_exp_f32 v51, v51
    v_exp_f32 v52, v52
    v_cvt_pk_bf16_f32 v77, v50, v51
    v_exp_f32 v53, v53
    v_exp_f32 v54, v54
    v_cvt_pk_bf16_f32 v78, v52, v53
    v_exp_f32 v55, v55
    s_nop 0
    v_cvt_pk_bf16_f32 v79, v54, v55
    v_and_b32 v72, v72, v184
    v_and_b32 v73, v73, v185
    v_and_b32 v74, v74, v186
    v_and_b32 v75, v75, v187
    v_and_b32 v76, v76, v188
    v_and_b32 v77, v77, v189
    v_and_b32 v78, v78, v190
    v_and_b32 v79, v79, v191
    s_waitcnt lgkmcnt(0)
    v_mfma_f32_32x32x16_bf16 v[40:55], v[16:19], v[8:11], v[120:135]
    v_exp_f32 v56, v56
    ds_read_b64_tr_b16 v[32:33], v193 offset:1024
    v_exp_f32 v57, v57
    ds_read_b64_tr_b16 v[34:35], v194 offset:1024
    v_exp_f32 v58, v58
    v_cvt_pk_bf16_f32 v80, v56, v57
    v_exp_f32 v59, v59
    ds_read_b64_tr_b16 v[36:37], v193 offset:1536
    v_exp_f32 v60, v60
    v_cvt_pk_bf16_f32 v81, v58, v59
    v_mfma_f32_32x32x16_bf16 v[88:103], v[24:27], v[72:75], v[88:103]
    v_exp_f32 v61, v61
    ds_read_b64_tr_b16 v[38:39], v194 offset:1536
    v_exp_f32 v62, v62
    v_cvt_pk_bf16_f32 v82, v60, v61
    v_exp_f32 v63, v63
    ds_read_b128 v[20:23], v192 offset:1024
    v_exp_f32 v64, v64
    v_cvt_pk_bf16_f32 v83, v62, v63
    v_mfma_f32_32x32x16_bf16 v[88:103], v[28:31], v[76:79], v[88:103]
    v_exp_f32 v65, v65
    v_add_u32 v192, 0xfffff800, v192
    v_exp_f32 v66, v66
    v_cvt_pk_bf16_f32 v84, v64, v65
    v_exp_f32 v67, v67
    v_add_u32 v193, v195, v193
    v_exp_f32 v68, v68
    v_cvt_pk_bf16_f32 v85, v66, v67
    v_exp_f32 v69, v69
    v_add_u32 v194, v195, v194
    v_exp_f32 v70, v70
    v_cvt_pk_bf16_f32 v86, v68, v69
    v_exp_f32 v71, v71
    s_nop 0
    v_cvt_pk_bf16_f32 v87, v70, v71
    v_and_b32 v80, v80, v184
    v_and_b32 v81, v81, v185
    v_and_b32 v82, v82, v186
    v_and_b32 v83, v83, v187
    v_and_b32 v84, v84, v188
    v_and_b32 v85, v85, v189
    v_and_b32 v86, v86, v190
    v_and_b32 v87, v87, v191
L_a2_nofar:
    s_waitcnt lgkmcnt(0)
    s_nop 1
    v_mfma_f32_32x32x16_bf16 v[104:119], v[32:35], v[80:83], v[104:119]
    v_mfma_f32_32x32x16_bf16 v[104:119], v[36:39], v[84:87], v[104:119]
    v_and_b32 v2, 31, v1
    s_lshl_b32 s36, s66, 5
    v_add_u32 v2, s36, v2
    v_lshlrev_b32 v3, 4, v2
    buffer_load_dwordx4 v[236:239], v3, s[32:35], 0 offen offset:0 sc1
    v_lshlrev_b32 v2, 10, v2
    v_lshrrev_b32 v3, 5, v1
    v_lshl_add_u32 v3, v3, 3, v2
    s_lshl_b32 s36, s67, 7
    s_lshl_b32 s37, s65, 6
    s_add_u32 s73, s36, s37
    buffer_load_dwordx2 v[224:225], v3, s[8:11], s73 offen offset:0
    buffer_load_dwordx2 v[226:227], v3, s[8:11], s73 offen offset:16
    buffer_load_dwordx2 v[228:229], v3, s[8:11], s73 offen offset:32
    buffer_load_dwordx2 v[230:231], v3, s[8:11], s73 offen offset:48
    s_waitcnt vmcnt(0) lgkmcnt(0)
    s_barrier
    s_lshl_b32 s36, s65, 6
    v_xor_b32 v192, s36, v254
    v_xor_b32 v193, 64, v192
    v_add_u32 v194, 0x10000, v192
    v_add_u32 v195, 0x10000, v193
    v_add_u32 v196, 0x20000, v192
    v_add_u32 v197, 0x20000, v193
    ds_read_b64_tr_b16 v[128:129], v192 offset:49152
    ds_read_b64_tr_b16 v[130:131], v192 offset:50176
    ds_read_b64_tr_b16 v[132:133], v193 offset:49152
    ds_read_b64_tr_b16 v[134:135], v193 offset:50176
    ds_read_b64_tr_b16 v[136:137], v192 offset:51200
    ds_read_b64_tr_b16 v[138:139], v192 offset:52224
    ds_read_b64_tr_b16 v[140:141], v193 offset:51200
    ds_read_b64_tr_b16 v[142:143], v193 offset:52224
    ds_read_b64_tr_b16 v[144:145], v192 offset:53248
    ds_read_b64_tr_b16 v[146:147], v192 offset:54272
    ds_read_b64_tr_b16 v[148:149], v193 offset:53248
    ds_read_b64_tr_b16 v[150:151], v193 offset:54272
    ds_read_b64_tr_b16 v[152:153], v192 offset:55296
    ds_read_b64_tr_b16 v[154:155], v192 offset:56320
    ds_read_b64_tr_b16 v[156:157], v193 offset:55296
    ds_read_b64_tr_b16 v[158:159], v193 offset:56320
    ds_read_b64_tr_b16 v[160:161], v196 offset:0
    ds_read_b64_tr_b16 v[162:163], v196 offset:1024
    ds_read_b64_tr_b16 v[164:165], v197 offset:0
    ds_read_b64_tr_b16 v[166:167], v197 offset:1024
    ds_read_b64_tr_b16 v[168:169], v196 offset:2048
    ds_read_b64_tr_b16 v[170:171], v196 offset:3072
    ds_read_b64_tr_b16 v[172:173], v197 offset:2048
    ds_read_b64_tr_b16 v[174:175], v197 offset:3072
    ds_read_b64_tr_b16 v[176:177], v196 offset:4096
    ds_read_b64_tr_b16 v[178:179], v196 offset:5120
    ds_read_b64_tr_b16 v[180:181], v197 offset:4096
    ds_read_b64_tr_b16 v[182:183], v197 offset:5120
    ds_read_b64_tr_b16 v[184:185], v196 offset:6144
    ds_read_b64_tr_b16 v[186:187], v196 offset:7168
    ds_read_b64_tr_b16 v[188:189], v197 offset:6144
    ds_read_b64_tr_b16 v[190:191], v197 offset:7168
    s_waitcnt lgkmcnt(0)
    s_barrier
    s_add_u32 m0, s72, 49152
    s_add_u32 s68, s68, 16384
    buffer_load_dwordx4 v252, s[24:27], s68 offen lds
    s_add_u32 m0, s72, 51200
    s_add_u32 s68, s68, 16384
    buffer_load_dwordx4 v252, s[24:27], s68 offen lds
    s_add_u32 m0, s72, 53248
    s_add_u32 s68, s68, 16384
    buffer_load_dwordx4 v252, s[24:27], s68 offen lds
    s_add_u32 m0, s72, 55296
    s_add_u32 s68, s68, 16384
    buffer_load_dwordx4 v252, s[24:27], s68 offen lds
    s_add_u32 m0, s72, 131072
    s_add_u32 s68, s68, 16384
    buffer_load_dwordx4 v252, s[24:27], s68 offen lds
    s_add_u32 m0, s72, 133120
    s_add_u32 s68, s68, 16384
    buffer_load_dwordx4 v252, s[24:27], s68 offen lds
    s_add_u32 m0, s72, 135168
    s_add_u32 s68, s68, 16384
    buffer_load_dwordx4 v252, s[24:27], s68 offen lds
    s_add_u32 m0, s72, 137216
    s_add_u32 s68, s68, 16384
    buffer_load_dwordx4 v252, s[24:27], s68 offen lds
    s_mov_b32 s55, 0
L_slow_hp:
    s_lshl_b32 s36, s98, 8
    s_add_u32 s36, s36, 17836032
    v_lshlrev_b32 v2, 2, v1
    buffer_load_dword v124, v2, s[32:35], s36 offen sc1
    s_waitcnt vmcnt(0)
    v_cmp_eq_u32 vcc, s47, v124
    s_add_u32 s55, s55, 1
    s_cmp_eq_u64 vcc, -1
    s_cbranch_scc1 L_slow_hok
    s_sleep 1
    s_cmp_lt_u32 s55, 65536
    s_cbranch_scc1 L_slow_hp
L_slow_hok:
    buffer_load_dwordx4 a[0:3], v253, s[32:35], s70 offen offset:0 sc1
    buffer_load_dwordx4 a[4:7], v253, s[32:35], s70 offen offset:1024 sc1
    buffer_load_dwordx4 a[8:11], v253, s[32:35], s70 offen offset:2048 sc1
    buffer_load_dwordx4 a[12:15], v253, s[32:35], s70 offen offset:3072 sc1
    s_add_u32 s70, s70, 4096
    buffer_load_dwordx4 a[16:19], v253, s[32:35], s70 offen offset:0 sc1
    buffer_load_dwordx4 a[20:23], v253, s[32:35], s70 offen offset:1024 sc1
    buffer_load_dwordx4 a[24:27], v253, s[32:35], s70 offen offset:2048 sc1
    buffer_load_dwordx4 a[28:31], v253, s[32:35], s70 offen offset:3072 sc1
    s_add_u32 s70, s70, 4096
    buffer_load_dwordx4 a[32:35], v253, s[32:35], s70 offen offset:0 sc1
    buffer_load_dwordx4 a[36:39], v253, s[32:35], s70 offen offset:1024 sc1
    buffer_load_dwordx4 a[40:43], v253, s[32:35], s70 offen offset:2048 sc1
    buffer_load_dwordx4 a[44:47], v253, s[32:35], s70 offen offset:3072 sc1
    s_add_u32 s70, s70, 4096
    s_waitcnt vmcnt(0)
    s_nop 7
    s_nop 7
    s_branch L_att_fin
L_ga_spin:
    s_mov_b32 s55, 0
L_ga_sp2:
    s_sleep 1
    v_and_b32 v6, 31, v1
    v_lshrrev_b32 v7, 5, v1
    s_sub_u32 s36, s52, s51
    v_mul_i32_i24 v7, s36, v7
    v_add_u32 v7, s51, v7
    v_lshl_add_u32 v6, v7, 5, v6
    v_lshlrev_b32 v6, 4, v6
    buffer_load_dwordx4 v[96:99], v6, s[32:35], 0 offen offset:0 sc1
    s_lshl_b32 s36, s5, 1
    s_add_u32 s36, s36, s41
    s_lshl_b32 s36, s36, 12
    s_add_u32 s36, s36, 65536
    v_lshlrev_b32 v6, 4, v1
    buffer_load_dwordx4 v[104:107], v6, s[32:35], s36 offen offset:0 sc1
    buffer_load_dwordx4 v[108:111], v6, s[32:35], s36 offen offset:1024 sc1
    buffer_load_dwordx4 v[112:115], v6, s[32:35], s36 offen offset:2048 sc1
    buffer_load_dwordx4 v[116:119], v6, s[32:35], s36 offen offset:3072 sc1
    s_waitcnt vmcnt(0)
    v_min3_u32 v2, v98, v105, v107
    v_max3_u32 v3, v98, v105, v107
    v_min3_u32 v2, v2, v109, v111
    v_max3_u32 v3, v3, v109, v111
    v_min3_u32 v2, v2, v113, v115
    v_max3_u32 v3, v3, v113, v115
    v_min3_u32 v2, v2, v117, v119
    v_max3_u32 v3, v3, v117, v119
    v_xor_b32 v2, s47, v2
    v_xor_b32 v3, s47, v3
    v_or_b32 v2, v2, v3
    v_cmp_eq_u32 vcc, 0, v2
    s_add_u32 s55, s55, 1
    s_cmp_eq_u64 vcc, -1
    s_cbranch_scc1 L_ga_ok
    s_cmp_lt_u32 s55, 65536
    s_cbranch_scc1 L_ga_sp2
    s_branch L_ga_ok
L_gb_spin:
    s_mov_b32 s55, 0
L_gb_sp2:
    s_sleep 1
    buffer_load_dwordx4 v[96:99], v253, s[32:35], s80 offen offset:0 sc1
    buffer_load_dwordx4 v[100:103], v253, s[32:35], s80 offen offset:1024 sc1
    buffer_load_dwordx4 v[104:107], v253, s[32:35], s80 offen offset:2048 sc1
    buffer_load_dwordx4 v[108:111], v253, s[32:35], s80 offen offset:3072 sc1
    buffer_load_dwordx4 v[112:115], v253, s[32:35], s81 offen offset:0 sc1
    buffer_load_dwordx4 v[116:119], v253, s[32:35], s81 offen offset:1024 sc1
    buffer_load_dwordx4 v[120:123], v253, s[32:35], s81 offen offset:2048 sc1
    buffer_load_dwordx4 v[124:127], v253, s[32:35], s81 offen offset:3072 sc1
    s_waitcnt vmcnt(0)
    v_min3_u32 v2, v99, v103, v107
    v_max3_u32 v3, v99, v103, v107
    v_min3_u32 v2, v2, v111, v115
    v_max3_u32 v3, v3, v111, v115
    v_min3_u32 v2, v2, v119, v123
    v_max3_u32 v3, v3, v119, v123
    v_min_u32 v2, v2, v127
    v_max_u32 v3, v3, v127
    v_xor_b32 v2, s47, v2
    v_xor_b32 v3, s47, v3
    v_or_b32 v2, v2, v3
    v_cmp_eq_u32 vcc, 0, v2
    s_add_u32 s55, s55, 1
    s_cmp_eq_u64 vcc, -1
    s_cbranch_scc1 L_gb_ok
    s_cmp_lt_u32 s55, 65536
    s_cbranch_scc1 L_gb_sp2
    s_branch L_gb_ok
L_kv_spin:
    s_mov_b32 s55, 0
L_kv_sp2:
    s_sleep 1
    buffer_load_dwordx2 v[68:69], v28, s[32:35], 0 offen sc1
    s_waitcnt vmcnt(0)
    v_bfe_u32 v2, v1, 2, 2
    v_min_u32 v2, 2, v2
    v_mov_b32 v3, s47
    v_cmp_gt_u32 vcc, v2, s4
    s_nop 1
    v_cndmask_b32 v68, v68, v3, vcc
    v_cmp_eq_u32 vcc, s47, v68
    s_add_u32 s55, s55, 1
    s_cmp_eq_u64 vcc, -1
    s_cbranch_scc1 L_kv_ok
    s_cmp_lt_u32 s55, 65536
    s_cbranch_scc1 L_kv_sp2
    s_branch L_kv_ok
L_hp_spin:
    s_mov_b32 s55, 0
L_hp_sp2:
    s_sleep 1
    s_lshl_b32 s36, s98, 8
    s_add_u32 s36, s36, 17836032
    v_lshlrev_b32 v2, 2, v1
    buffer_load_dword v124, v2, s[32:35], s36 offen sc1
    s_waitcnt vmcnt(0)
    v_cmp_eq_u32 vcc, s47, v124
    s_add_u32 s55, s55, 1
    s_cmp_eq_u64 vcc, -1
    s_cbranch_scc1 L_hp_ok
    s_cmp_lt_u32 s55, 65536
    s_cbranch_scc1 L_hp_sp2
    s_branch L_hp_ok
L_ap_spin:
    s_mov_b32 s55, 0
L_ap_sp2:
    s_sleep 1
    s_lshl_b32 s36, s98, 8
    s_add_u32 s36, s36, 17840128
    v_lshlrev_b32 v2, 2, v1
    buffer_load_dword v124, v2, s[32:35], s36 offen sc1
    s_waitcnt vmcnt(0)
    v_cmp_eq_u32 vcc, s47, v124
    s_add_u32 s55, s55, 1
    s_cmp_eq_u64 vcc, -1
    s_cbranch_scc1 L_ap_ok
    s_cmp_lt_u32 s55, 65536
    s_cbranch_scc1 L_ap_sp2
    s_branch L_ap_ok
L_st_spin:
    s_mov_b32 s55, 0
L_st_sp2:
    s_sleep 1
    v_and_b32 v2, 31, v1
    s_lshl_b32 s36, s66, 5
    v_add_u32 v2, s36, v2
    v_lshlrev_b32 v3, 4, v2
    buffer_load_dwordx4 v[236:239], v3, s[32:35], 0 offen offset:0 sc1
    s_waitcnt vmcnt(0)
    v_cmp_eq_u32 vcc, s47, v238
    s_add_u32 s55, s55, 1
    s_cmp_eq_u64 vcc, -1
    s_cbranch_scc1 L_st_ok
    s_cmp_lt_u32 s55, 65536
    s_cbranch_scc1 L_st_sp2
    s_branch L_st_ok
L_end:
    s_endpgm
.section .rodata,"a"
.p2align 6
.amdhsa_kernel recurrent_scan__sliding_block__dense_activation_relu__prompt_kernel
  .amdhsa_next_free_vgpr 512
  .amdhsa_next_free_sgpr 102
  .amdhsa_accum_offset 256
  .amdhsa_group_segment_fixed_size 0
  .amdhsa_kernarg_size 72
  .amdhsa_user_sgpr_count 2
  .amdhsa_user_sgpr_kernarg_segment_ptr 1
  .amdhsa_system_sgpr_workgroup_id_x 1
  .amdhsa_float_denorm_mode_32 3
.end_amdhsa_kernel
```
